```python
import torch

def _softmax(x, axis=-1):
    return torch.softmax(x, dim=axis)
def _gelu(x):
    return torch.nn.functional.gelu(x, approximate="tanh")
def _silu(x):
    return torch.nn.functional.silu(x)
def _sigmoid(x):
    return torch.sigmoid(x)
def _layernorm(x, axis=-1, eps=1e-5):
    m = x.mean(dim=axis, keepdim=True)
    v = x.var(dim=axis, keepdim=True, unbiased=False)
    return (x - m) / torch.sqrt(v + eps)
def _scatter_add(tgt, idx, src, axis=0):
    return tgt.clone().index_add_(axis, idx, src)
def _segment_sum(src, seg, n):
    out = torch.zeros((n,) + src.shape[1:], dtype=src.dtype)
    return out.index_add_(0, seg, src)
def _pad(x, pw):
    flat = tuple(v for pair in reversed(pw) for v in pair)
    return torch.nn.functional.pad(x, flat)

kernel_name = 'gated_mix__grouped_kv_mqa__grouped_kv_mqa__prompt'

def setup_inputs():

    _w = (lambda a: (lambda t: t.to(torch.bfloat16) if t.is_floating_point() else t)(torch.as_tensor(a)))
    def _A_setup():
        B, S, D, H = 1, 2048, 1024, 32
        Dh = D // H
        return {
            "x": _w((lambda *s: torch.randn(*s, dtype=torch.bfloat16) * 0.05)(B, S, D)),
            "wq": _w((lambda *s: torch.randn(*s, dtype=torch.bfloat16) * 0.8)(D, H * Dh)),
            "wk": _w((lambda *s: torch.randn(*s, dtype=torch.bfloat16) * 0.8)(D, Dh)),
            "wv": _w((lambda *s: torch.randn(*s, dtype=torch.bfloat16) * 0.05)(D, Dh)),
            "wo": _w((lambda *s: torch.randn(*s, dtype=torch.bfloat16) * 0.05)(H * Dh, D)),
        }
    _A_in = _A_setup()

    def _B_setup():
        B, S, D, H = 1, 2048, 1024, 32
        Dh = D // H
        return {
            "x": _w((lambda *s: torch.randn(*s, dtype=torch.bfloat16) * 0.05)(B, S, D)),
            "wq": _w((lambda *s: torch.randn(*s, dtype=torch.bfloat16) * 0.8)(D, H * Dh)),
            "wk": _w((lambda *s: torch.randn(*s, dtype=torch.bfloat16) * 0.8)(D, Dh)),
            "wv": _w((lambda *s: torch.randn(*s, dtype=torch.bfloat16) * 0.05)(D, Dh)),
            "wo": _w((lambda *s: torch.randn(*s, dtype=torch.bfloat16) * 0.05)(H * Dh, D)),
        }
    _B_in = _B_setup()

    return {
        "A_x": _A_in["x"],
        "A_wq": _A_in["wq"],
        "A_wk": _A_in["wk"],
        "A_wv": _A_in["wv"],
        "A_wo": _A_in["wo"],
        "B_x": _B_in["x"],
        "B_wq": _B_in["wq"],
        "B_wk": _B_in["wk"],
        "B_wv": _B_in["wv"],
        "B_wo": _B_in["wo"],
        "gate_w": _w((lambda *s: torch.randn(*s, dtype=torch.bfloat16) * 0.05)(1024) * 16.0),
    }

def reference(A_x, A_wq, A_wk, A_wv, A_wo, B_x, B_wq, B_wk, B_wv, B_wo, gate_w):
    def _A_ref(x, wq, wk, wv, wo):
        B, S, D = x.shape
        H = 32
        Dh = D // H
        q = (lambda x, *d: x.permute(*d))((x @ wq).reshape(B, S, H, Dh), 0, 2, 1, 3)
        k = x @ wk
        v = x @ wv
        scores = torch.einsum("bhqd,bkd->bhqk", q, k) * (Dh ** -0.5)
        p = _softmax(scores, axis=-1)
        o = torch.einsum("bhqk,bkd->bhqd", p, v)
        return (lambda x, *d: x.permute(*d))(o, 0, 2, 1, 3).reshape(B, S, H * Dh) @ wo

    def _B_ref(x, wq, wk, wv, wo):
        B, S, D = x.shape
        H = 32
        Dh = D // H
        q = (lambda x, *d: x.permute(*d))((x @ wq).reshape(B, S, H, Dh), 0, 2, 1, 3)
        k = x @ wk
        v = x @ wv
        scores = torch.einsum("bhqd,bkd->bhqk", q, k) * (Dh ** -0.5)
        p = _softmax(scores, axis=-1)
        o = torch.einsum("bhqk,bkd->bhqd", p, v)
        return (lambda x, *d: x.permute(*d))(o, 0, 2, 1, 3).reshape(B, S, H * Dh) @ wo

    x = A_x
    g = _sigmoid((x * gate_w).sum(-1, keepdims=True))
    a = _A_ref(x, A_wq, A_wk, A_wv, A_wo)
    b = _B_ref(x, B_wq, B_wk, B_wv, B_wo)
    return g * a + (1 - g) * b
```

```asm
; @launch grid=(256,1,1) block=(512,1,1) lds=163840
.amdgcn_target "amdgcn-amd-amdhsa--gfx950"
.text
.globl gated_mix__grouped_kv_mqa__grouped_kv_mqa__prompt_kernel
.p2align 8
.type gated_mix__grouped_kv_mqa__grouped_kv_mqa__prompt_kernel,@function
gated_mix__grouped_kv_mqa__grouped_kv_mqa__prompt_kernel:
    s_cmp_ge_u32 s2, 256
    s_cbranch_scc1 END2
    s_load_dwordx4 s[40:43], s[0:1], 0
    s_load_dwordx4 s[44:47], s[0:1], 16
    s_load_dwordx4 s[48:51], s[0:1], 48
    s_load_dwordx2 s[52:53], s[0:1], 64
    s_load_dwordx2 s[54:55], s[0:1], 80
    s_load_dwordx4 s[56:59], s[0:1], 88
    s_load_dwordx2 s[60:61], s[0:1], 104
    v_lshrrev_b32 v8, 6, v0
    v_and_b32 v1, 63, v0
    v_readfirstlane_b32 s24, v8
    s_and_b32 s29, s2, 1
    s_lshl_b32 s29, s29, 3
    s_bfe_u32 s30, s2, 0x30003
    s_add_u32 s26, s29, s30
    s_bfe_u32 s28, s2, 0x20001
    s_lshl_b32 s31, s28, 2
    s_lshr_b32 s32, s2, 6
    s_add_u32 s25, s31, s32
    s_lshl_b32 s29, s32, 1
    s_add_u32 s28, s28, s29
    s_and_b32 s29, s30, 4
    s_add_u32 s28, s28, s29
    s_and_b32 s28, s28, 7
    s_and_b32 s27, s2, 7
    s_lshl_b32 s27, s27, 1
    v_lshlrev_b32 v2, 4, v1
    s_cmp_lt_u32 s24, 4
    s_cbranch_scc1 COMPUTE
    s_sub_u32 s24, s24, 4
    v_lshrrev_b32 v8, 3, v1
    v_lshlrev_b32 v8, 11, v8
    v_lshrrev_b32 v9, 4, v1
    v_and_b32 v10, 7, v1
    v_xor_b32 v10, v10, v9
    v_lshl_add_u32 v16, v10, 4, v8
    v_xor_b32 v10, 4, v10
    v_lshl_add_u32 v17, v10, 4, v8
    v_add_u32 v17, 15360, v17
    v_add_u32 v18, 30720, v16
    v_add_u32 v19, 30720, v17
    s_lshl_b32 s34, s25, 18
    s_lshl_b32 s36, s24, 12
    s_mov_b32 s38, 0
    s_bitcmp1_b32 s2, 0
    s_cbranch_scc1 H_ODD
    s_and_b32 s29, s26, 3
    s_lshl_b32 s29, s29, 16
    s_add_u32 s33, s34, s29
    s_and_b32 s29, s24, 1
    s_lshl_b32 s29, s29, 15
    s_add_u32 s33, s33, s29
    s_lshr_b32 s29, s24, 1
    s_lshl_b32 s29, s29, 7
    s_add_u32 s33, s33, s29
    s_lshl_b32 s35, s24, 11
    s_mov_b32 s37, s35
    s_waitcnt lgkmcnt(0)
    s_mov_b32 s4, s40
    s_and_b32 s5, s41, 0xffff
    s_mov_b32 s6, 0x400000
    s_mov_b32 s7, 0x20000
    s_bitcmp1_b32 s26, 2
    s_cselect_b32 s44, s50, s44
    s_cselect_b32 s45, s51, s45
    s_cselect_b32 s46, s52, s46
    s_cselect_b32 s47, s53, s47
    s_mov_b32 s12, s44
    s_and_b32 s13, s45, 0xffff
    s_mov_b32 s14, 0x10000
    s_mov_b32 s15, 0x20000
    s_mov_b32 s20, s46
    s_and_b32 s21, s47, 0xffff
    s_mov_b32 s22, 0x10000
    s_mov_b32 s23, 0x20000
H_KV:
    s_cmp_lt_u32 s38, 3
    s_cbranch_scc1 H_KV2
    s_waitcnt vmcnt(12)
    s_barrier
H_KV2:
    s_lshl_b32 s29, s28, 8
    s_add_u32 s29, s29, s33
    s_mov_b32 m0, s37
    s_lshl_b32 s30, s28, 13
    buffer_load_dwordx4 v16, s[4:7], s29 offen offset:0 lds
    buffer_load_dwordx4 v17, s[4:7], s29 offen offset:1024 lds
    s_add_u32 m0, s37, 8192
    s_add_u32 s30, s30, s35
    buffer_load_dwordx4 v2, s[12:15], s30 offen offset:0 lds
    buffer_load_dwordx4 v2, s[12:15], s30 offen offset:1024 lds
    s_add_u32 m0, s37, 16384
    s_add_u32 s28, s28, 1
    buffer_load_dwordx4 v2, s[20:23], s30 offen offset:0 lds
    buffer_load_dwordx4 v2, s[20:23], s30 offen offset:1024 lds
    s_and_b32 s28, s28, 7
    s_add_u32 s37, s37, 32768
    s_and_b32 s37, s37, 0x1ffff
    s_add_u32 s38, s38, 1
    s_cmp_lt_u32 s38, 8
    s_cbranch_scc1 H_KV
    s_mov_b32 s38, 0
    s_mov_b32 s62, 1
    s_waitcnt vmcnt(12)
    s_barrier
    s_branch H_Q
H_ODD:
    s_mov_b32 s62, 99
    s_waitcnt lgkmcnt(0)
    s_mov_b32 s4, s40
    s_and_b32 s5, s41, 0xffff
    s_mov_b32 s6, 0x400000
    s_mov_b32 s7, 0x20000
    s_mov_b32 s42, s48
    s_mov_b32 s43, s49
H_Q:
    s_mov_b32 s37, s36
    v_bfe_u32 v10, v1, 1, 3
    v_lshlrev_b32 v8, 1, v9
    v_xor_b32 v10, v10, v8
    v_lshlrev_b32 v10, 5, v10
    v_lshl_add_u32 v10, v9, 11, v10
    v_and_b32 v8, 1, v1
    v_lshl_add_u32 v20, v8, 4, v10
    v_add_u32 v21, 7168, v20
    v_xor_b32 v10, 32, v20
    v_add_u32 v22, 14336, v10
    v_add_u32 v23, 21504, v10
    s_mov_b32 s8, s42
    s_and_b32 s9, s43, 0xffff
    s_mov_b32 s10, 0x200000
    s_mov_b32 s11, 0x20000
    s_lshl_b32 s29, s24, 16
    s_add_u32 s34, s34, s29
    s_and_b32 s35, s26, 7
    s_lshl_b32 s35, s35, 8
    s_lshl_b32 s29, s24, 15
    s_add_u32 s35, s35, s29
H_LOOP:
    s_cmp_ge_u32 s38, 5
    s_cbranch_scc1 H_W16
    s_cmp_lg_u32 s38, s62
    s_cbranch_scc1 H_NX
    s_waitcnt vmcnt(14)
    s_barrier
    s_waitcnt vmcnt(8)
    s_barrier
H_NX:
    s_bitcmp1_b32 19, s38
    s_cbranch_scc1 H_ISSUE
    s_waitcnt vmcnt(8)
H_W16:
    s_waitcnt vmcnt(16)
    s_barrier
H_ISSUE:
    s_lshl_b32 s29, s27, 7
    s_add_u32 s29, s29, s34
    s_mov_b32 m0, s37
    s_lshl_b32 s30, s27, 17
    buffer_load_dwordx4 v16, s[4:7], s29 offen offset:0 lds
    buffer_load_dwordx4 v17, s[4:7], s29 offen offset:1024 lds
    buffer_load_dwordx4 v18, s[4:7], s29 offen offset:2048 lds
    buffer_load_dwordx4 v19, s[4:7], s29 offen offset:3072 lds
    s_add_u32 m0, s37, 16384
    s_add_u32 s30, s30, s35
    buffer_load_dwordx4 v20, s[8:11], s30 offen offset:0 lds
    buffer_load_dwordx4 v21, s[8:11], s30 offen offset:1024 lds
    buffer_load_dwordx4 v22, s[8:11], s30 offen offset:2048 lds
    buffer_load_dwordx4 v23, s[8:11], s30 offen offset:3072 lds
    s_add_u32 s27, s27, 1
    s_and_b32 s27, s27, 15
    s_add_u32 s37, s37, 32768
    s_and_b32 s37, s37, 0x1ffff
    s_add_u32 s38, s38, 1
    s_cmp_lt_u32 s38, 16
    s_cbranch_scc1 H_LOOP
    s_load_dwordx2 s[40:41], s[0:1], 32
    s_load_dwordx2 s[42:43], s[0:1], 72
    s_mov_b32 s16, s60
    s_and_b32 s17, s61, 0xffff
    s_mov_b32 s18, 0x900000
    s_mov_b32 s19, 0x20000
    s_lshr_b32 s32, s26, 3
    s_lshl_b32 s32, s32, 18
    s_add_u32 s32, s32, s36
    s_lshr_b32 s33, s2, 4
    s_lshl_b32 s33, s33, 14
    s_waitcnt vmcnt(16)
    s_barrier
    s_waitcnt vmcnt(8)
    s_barrier
    s_add_u32 m0, s36, 131072
    s_add_u32 s31, s32, s33
    buffer_load_dwordx4 v2, s[16:19], s31 offen offset:0 sc1 lds
    buffer_load_dwordx4 v2, s[16:19], s31 offen offset:1024 sc1 lds
    buffer_load_dwordx4 v2, s[16:19], s31 offen offset:2048 sc1 lds
    buffer_load_dwordx4 v2, s[16:19], s31 offen offset:3072 sc1 lds
    s_add_u32 s33, s33, 16384
    s_and_b32 s33, s33, 0x3ffff
    s_add_u32 m0, s36, 147456
    s_add_u32 s31, s32, s33
    buffer_load_dwordx4 v2, s[16:19], s31 offen offset:0 sc1 lds
    buffer_load_dwordx4 v2, s[16:19], s31 offen offset:1024 sc1 lds
    buffer_load_dwordx4 v2, s[16:19], s31 offen offset:2048 sc1 lds
    buffer_load_dwordx4 v2, s[16:19], s31 offen offset:3072 sc1 lds
    s_add_u32 s33, s33, 16384
    s_and_b32 s33, s33, 0x3ffff
    s_waitcnt vmcnt(8)
    s_barrier
    v_lshrrev_b32 v8, 3, v1
    v_lshlrev_b32 v8, 11, v8
    v_lshrrev_b32 v10, 1, v1
    v_lshrrev_b32 v12, 4, v1
    v_xor_b32 v10, v10, v12
    v_and_b32 v10, 3, v10
    v_lshl_add_u32 v8, v10, 5, v8
    v_and_b32 v10, 1, v1
    v_lshl_add_u32 v16, v10, 4, v8
    v_bfe_u32 v8, v1, 2, 3
    v_lshrrev_b32 v10, 5, v1
    v_lshl_add_u32 v10, v10, 4, v8
    v_lshlrev_b32 v10, 7, v10
    v_lshrrev_b32 v8, 1, v8
    v_lshl_add_u32 v10, v8, 5, v10
    v_and_b32 v8, 3, v1
    v_lshl_add_u32 v10, v8, 3, v10
    v_add_u32 v24, s36, v10
    v_xor_b32 v25, 32, v24
    v_xor_b32 v26, 64, v24
    v_xor_b32 v27, 96, v24
    v_add_u32 v17, 15360, v16
    v_add_u32 v18, 30720, v16
    v_add_u32 v19, 46080, v16
    s_lshl_b32 s34, s26, 7
    s_lshl_b32 s29, s24, 17
    s_add_u32 s34, s34, s29
    s_bfe_u32 s29, s2, 0x20001
    s_lshr_b32 s27, s26, 3
    s_lshl_b32 s27, s27, 2
    s_add_u32 s27, s27, s29
    s_waitcnt lgkmcnt(0)
    s_and_b32 s41, s41, 0xffff
    s_and_b32 s43, s43, 0xffff
    s_mov_b32 s10, 0x200000
    s_mov_b32 s11, 0x20000
    v_mov_b32 v9, 0
    v_mov_b32 v11, 64
    v_add_u32 v13, s36, v2
    v_add_u32 v14, 0x10000, v13
    v_add_u32 v15, 0x18000, v13
    s_lshl_b32 s44, s25, 8
    s_add_u32 s44, s44, 589824
    s_cmp_eq_u32 s24, 0
    s_cselect_b32 s45, s44, 0x40000000
    v_lshlrev_b32 v12, 7, v1
    s_lshl_b32 s46, s25, 19
    s_and_b32 s29, s26, 7
    s_lshl_b32 s29, s29, 13
    s_add_u32 s46, s46, s29
    s_add_u32 s46, s46, 1048576
    s_waitcnt vmcnt(4)
    s_barrier
    s_add_u32 m0, s36, 98304
    s_add_u32 s31, s32, s33
    buffer_load_dwordx4 v2, s[16:19], s31 offen offset:0 sc1 lds
    buffer_load_dwordx4 v2, s[16:19], s31 offen offset:1024 sc1 lds
    buffer_load_dwordx4 v2, s[16:19], s31 offen offset:2048 sc1 lds
    buffer_load_dwordx4 v2, s[16:19], s31 offen offset:3072 sc1 lds
    s_add_u32 s33, s33, 16384
    s_and_b32 s33, s33, 0x3ffff
    s_add_u32 m0, s36, 114688
    s_add_u32 s31, s32, s33
    buffer_load_dwordx4 v2, s[16:19], s31 offen offset:0 sc1 lds
    buffer_load_dwordx4 v2, s[16:19], s31 offen offset:1024 sc1 lds
    buffer_load_dwordx4 v2, s[16:19], s31 offen offset:2048 sc1 lds
    buffer_load_dwordx4 v2, s[16:19], s31 offen offset:3072 sc1 lds
    s_add_u32 s33, s33, 16384
    s_and_b32 s33, s33, 0x3ffff
    s_waitcnt vmcnt(8)
    s_barrier
    s_add_u32 m0, s36, 131072
    s_add_u32 s31, s32, s33
    buffer_load_dwordx4 v2, s[16:19], s31 offen offset:0 sc1 lds
    buffer_load_dwordx4 v2, s[16:19], s31 offen offset:1024 sc1 lds
    buffer_load_dwordx4 v2, s[16:19], s31 offen offset:2048 sc1 lds
    buffer_load_dwordx4 v2, s[16:19], s31 offen offset:3072 sc1 lds
    s_add_u32 s33, s33, 16384
    s_and_b32 s33, s33, 0x3ffff
    s_add_u32 s30, s27, 6
    s_bitcmp1_b32 s30, 2
    s_cselect_b32 s8, s42, s40
    s_cselect_b32 s9, s43, s41
    s_and_b32 s29, s30, 3
    s_lshl_b32 s29, s29, 19
    s_add_u32 m0, s36, 0
    s_add_u32 s29, s29, s34
    buffer_load_dwordx4 v16, s[8:11], s29 offen offset:0 lds
    buffer_load_dwordx4 v17, s[8:11], s29 offen offset:1024 lds
    buffer_load_dwordx4 v18, s[8:11], s29 offen offset:2048 lds
    buffer_load_dwordx4 v19, s[8:11], s29 offen offset:3072 lds
    s_add_u32 s30, s27, 7
    s_bitcmp1_b32 s30, 2
    s_cselect_b32 s8, s42, s40
    s_cselect_b32 s9, s43, s41
    s_and_b32 s29, s30, 3
    s_lshl_b32 s29, s29, 19
    s_add_u32 m0, s36, 16384
    s_add_u32 s29, s29, s34
    buffer_load_dwordx4 v16, s[8:11], s29 offen offset:0 lds
    buffer_load_dwordx4 v17, s[8:11], s29 offen offset:1024 lds
    buffer_load_dwordx4 v18, s[8:11], s29 offen offset:2048 lds
    buffer_load_dwordx4 v19, s[8:11], s29 offen offset:3072 lds
    s_waitcnt vmcnt(16)
    s_barrier
    s_add_u32 m0, s36, 147456
    s_add_u32 s31, s32, s33
    buffer_load_dwordx4 v2, s[16:19], s31 offen offset:0 sc1 lds
    buffer_load_dwordx4 v2, s[16:19], s31 offen offset:1024 sc1 lds
    buffer_load_dwordx4 v2, s[16:19], s31 offen offset:2048 sc1 lds
    buffer_load_dwordx4 v2, s[16:19], s31 offen offset:3072 sc1 lds
    s_add_u32 s33, s33, 16384
    s_and_b32 s33, s33, 0x3ffff
    s_add_u32 s30, s27, 0
    s_bitcmp1_b32 s30, 2
    s_cselect_b32 s8, s42, s40
    s_cselect_b32 s9, s43, s41
    s_and_b32 s29, s30, 3
    s_lshl_b32 s29, s29, 19
    s_add_u32 s29, s29, 0x10000
    s_add_u32 m0, s36, 32768
    s_add_u32 s29, s29, s34
    buffer_load_dwordx4 v16, s[8:11], s29 offen offset:0 lds
    buffer_load_dwordx4 v17, s[8:11], s29 offen offset:1024 lds
    buffer_load_dwordx4 v18, s[8:11], s29 offen offset:2048 lds
    buffer_load_dwordx4 v19, s[8:11], s29 offen offset:3072 lds
    s_add_u32 s30, s27, 1
    s_bitcmp1_b32 s30, 2
    s_cselect_b32 s8, s42, s40
    s_cselect_b32 s9, s43, s41
    s_and_b32 s29, s30, 3
    s_lshl_b32 s29, s29, 19
    s_add_u32 s29, s29, 0x10000
    s_add_u32 m0, s36, 49152
    s_add_u32 s29, s29, s34
    buffer_load_dwordx4 v16, s[8:11], s29 offen offset:0 lds
    buffer_load_dwordx4 v17, s[8:11], s29 offen offset:1024 lds
    buffer_load_dwordx4 v18, s[8:11], s29 offen offset:2048 lds
    buffer_load_dwordx4 v19, s[8:11], s29 offen offset:3072 lds
    s_waitcnt vmcnt(12)
    ds_read_b64_tr_b16 v[48:49], v24 offset:0
    s_waitcnt lgkmcnt(0)
    ds_read_b64_tr_b16 v[50:51], v24 offset:1024
    s_waitcnt lgkmcnt(0)
    ds_read_b64_tr_b16 v[52:53], v25 offset:0
    s_waitcnt lgkmcnt(0)
    ds_read_b64_tr_b16 v[54:55], v25 offset:1024
    s_waitcnt lgkmcnt(0)
    ds_read_b64_tr_b16 v[56:57], v26 offset:0
    s_waitcnt lgkmcnt(0)
    ds_read_b64_tr_b16 v[58:59], v26 offset:1024
    s_waitcnt lgkmcnt(0)
    ds_read_b64_tr_b16 v[60:61], v27 offset:0
    s_waitcnt lgkmcnt(0)
    ds_read_b64_tr_b16 v[62:63], v27 offset:1024
    s_waitcnt lgkmcnt(0)
    s_waitcnt lgkmcnt(0)
    ds_read_b64_tr_b16 v[64:65], v24 offset:16384
    s_waitcnt lgkmcnt(0)
    ds_read_b64_tr_b16 v[66:67], v24 offset:17408
    s_waitcnt lgkmcnt(0)
    ds_read_b64_tr_b16 v[68:69], v25 offset:16384
    s_waitcnt lgkmcnt(0)
    ds_read_b64_tr_b16 v[70:71], v25 offset:17408
    s_waitcnt lgkmcnt(0)
    ds_read_b64_tr_b16 v[72:73], v26 offset:16384
    s_waitcnt lgkmcnt(0)
    ds_read_b64_tr_b16 v[74:75], v26 offset:17408
    s_waitcnt lgkmcnt(0)
    ds_read_b64_tr_b16 v[76:77], v27 offset:16384
    s_waitcnt lgkmcnt(0)
    ds_read_b64_tr_b16 v[78:79], v27 offset:17408
    s_waitcnt lgkmcnt(0)
    s_waitcnt lgkmcnt(0)
    s_barrier
    s_add_u32 m0, s36, 98304
    s_add_u32 s31, s32, s33
    buffer_load_dwordx4 v2, s[16:19], s31 offen offset:0 sc1 lds
    buffer_load_dwordx4 v2, s[16:19], s31 offen offset:1024 sc1 lds
    buffer_load_dwordx4 v2, s[16:19], s31 offen offset:2048 sc1 lds
    buffer_load_dwordx4 v2, s[16:19], s31 offen offset:3072 sc1 lds
    s_add_u32 s33, s33, 16384
    s_and_b32 s33, s33, 0x3ffff
    s_add_u32 s30, s27, 2
    s_bitcmp1_b32 s30, 2
    s_cselect_b32 s8, s42, s40
    s_cselect_b32 s9, s43, s41
    s_and_b32 s29, s30, 3
    s_lshl_b32 s29, s29, 19
    s_add_u32 s29, s29, 0x10000
    s_add_u32 m0, s36, 0
    s_add_u32 s29, s29, s34
    buffer_load_dwordx4 v16, s[8:11], s29 offen offset:0 lds
    buffer_load_dwordx4 v17, s[8:11], s29 offen offset:1024 lds
    buffer_load_dwordx4 v18, s[8:11], s29 offen offset:2048 lds
    buffer_load_dwordx4 v19, s[8:11], s29 offen offset:3072 lds
    s_add_u32 s30, s27, 3
    s_bitcmp1_b32 s30, 2
    s_cselect_b32 s8, s42, s40
    s_cselect_b32 s9, s43, s41
    s_and_b32 s29, s30, 3
    s_lshl_b32 s29, s29, 19
    s_add_u32 s29, s29, 0x10000
    s_add_u32 m0, s36, 16384
    s_add_u32 s29, s29, s34
    buffer_load_dwordx4 v16, s[8:11], s29 offen offset:0 lds
    buffer_load_dwordx4 v17, s[8:11], s29 offen offset:1024 lds
    buffer_load_dwordx4 v18, s[8:11], s29 offen offset:2048 lds
    buffer_load_dwordx4 v19, s[8:11], s29 offen offset:3072 lds
    s_waitcnt vmcnt(12)
    ds_read_b64_tr_b16 v[80:81], v24 offset:32768
    s_waitcnt lgkmcnt(0)
    ds_read_b64_tr_b16 v[82:83], v24 offset:33792
    s_waitcnt lgkmcnt(0)
    ds_read_b64_tr_b16 v[84:85], v25 offset:32768
    s_waitcnt lgkmcnt(0)
    ds_read_b64_tr_b16 v[86:87], v25 offset:33792
    s_waitcnt lgkmcnt(0)
    ds_read_b64_tr_b16 v[88:89], v26 offset:32768
    s_waitcnt lgkmcnt(0)
    ds_read_b64_tr_b16 v[90:91], v26 offset:33792
    s_waitcnt lgkmcnt(0)
    ds_read_b64_tr_b16 v[92:93], v27 offset:32768
    s_waitcnt lgkmcnt(0)
    ds_read_b64_tr_b16 v[94:95], v27 offset:33792
    s_waitcnt lgkmcnt(0)
    s_waitcnt lgkmcnt(0)
    ds_read_b64_tr_b16 v[96:97], v24 offset:49152
    s_waitcnt lgkmcnt(0)
    ds_read_b64_tr_b16 v[98:99], v24 offset:50176
    s_waitcnt lgkmcnt(0)
    ds_read_b64_tr_b16 v[100:101], v25 offset:49152
    s_waitcnt lgkmcnt(0)
    ds_read_b64_tr_b16 v[102:103], v25 offset:50176
    s_waitcnt lgkmcnt(0)
    ds_read_b64_tr_b16 v[104:105], v26 offset:49152
    s_waitcnt lgkmcnt(0)
    ds_read_b64_tr_b16 v[106:107], v26 offset:50176
    s_waitcnt lgkmcnt(0)
    ds_read_b64_tr_b16 v[108:109], v27 offset:49152
    s_waitcnt lgkmcnt(0)
    ds_read_b64_tr_b16 v[110:111], v27 offset:50176
    s_waitcnt lgkmcnt(0)
    s_waitcnt lgkmcnt(0)
    s_barrier
    s_add_u32 m0, s36, 114688
    s_add_u32 s31, s32, s33
    buffer_load_dwordx4 v2, s[16:19], s31 offen offset:0 sc1 lds
    buffer_load_dwordx4 v2, s[16:19], s31 offen offset:1024 sc1 lds
    buffer_load_dwordx4 v2, s[16:19], s31 offen offset:2048 sc1 lds
    buffer_load_dwordx4 v2, s[16:19], s31 offen offset:3072 sc1 lds
    s_add_u32 s33, s33, 16384
    s_and_b32 s33, s33, 0x3ffff
    s_add_u32 s30, s27, 4
    s_bitcmp1_b32 s30, 2
    s_cselect_b32 s8, s42, s40
    s_cselect_b32 s9, s43, s41
    s_and_b32 s29, s30, 3
    s_lshl_b32 s29, s29, 19
    s_add_u32 s29, s29, 0x10000
    s_add_u32 m0, s36, 32768
    s_add_u32 s29, s29, s34
    buffer_load_dwordx4 v16, s[8:11], s29 offen offset:0 lds
    buffer_load_dwordx4 v17, s[8:11], s29 offen offset:1024 lds
    buffer_load_dwordx4 v18, s[8:11], s29 offen offset:2048 lds
    buffer_load_dwordx4 v19, s[8:11], s29 offen offset:3072 lds
    s_add_u32 s30, s27, 5
    s_bitcmp1_b32 s30, 2
    s_cselect_b32 s8, s42, s40
    s_cselect_b32 s9, s43, s41
    s_and_b32 s29, s30, 3
    s_lshl_b32 s29, s29, 19
    s_add_u32 s29, s29, 0x10000
    s_add_u32 m0, s36, 49152
    s_add_u32 s29, s29, s34
    buffer_load_dwordx4 v16, s[8:11], s29 offen offset:0 lds
    buffer_load_dwordx4 v17, s[8:11], s29 offen offset:1024 lds
    buffer_load_dwordx4 v18, s[8:11], s29 offen offset:2048 lds
    buffer_load_dwordx4 v19, s[8:11], s29 offen offset:3072 lds
    s_waitcnt vmcnt(12)
    ds_read_b64_tr_b16 v[112:113], v24 offset:0
    s_waitcnt lgkmcnt(0)
    ds_read_b64_tr_b16 v[114:115], v24 offset:1024
    s_waitcnt lgkmcnt(0)
    ds_read_b64_tr_b16 v[116:117], v25 offset:0
    s_waitcnt lgkmcnt(0)
    ds_read_b64_tr_b16 v[118:119], v25 offset:1024
    s_waitcnt lgkmcnt(0)
    ds_read_b64_tr_b16 v[120:121], v26 offset:0
    s_waitcnt lgkmcnt(0)
    ds_read_b64_tr_b16 v[122:123], v26 offset:1024
    s_waitcnt lgkmcnt(0)
    ds_read_b64_tr_b16 v[124:125], v27 offset:0
    s_waitcnt lgkmcnt(0)
    ds_read_b64_tr_b16 v[126:127], v27 offset:1024
    s_waitcnt lgkmcnt(0)
    s_waitcnt lgkmcnt(0)
    ds_read_b64_tr_b16 v[128:129], v24 offset:16384
    s_waitcnt lgkmcnt(0)
    ds_read_b64_tr_b16 v[130:131], v24 offset:17408
    s_waitcnt lgkmcnt(0)
    ds_read_b64_tr_b16 v[132:133], v25 offset:16384
    s_waitcnt lgkmcnt(0)
    ds_read_b64_tr_b16 v[134:135], v25 offset:17408
    s_waitcnt lgkmcnt(0)
    ds_read_b64_tr_b16 v[136:137], v26 offset:16384
    s_waitcnt lgkmcnt(0)
    ds_read_b64_tr_b16 v[138:139], v26 offset:17408
    s_waitcnt lgkmcnt(0)
    ds_read_b64_tr_b16 v[140:141], v27 offset:16384
    s_waitcnt lgkmcnt(0)
    ds_read_b64_tr_b16 v[142:143], v27 offset:17408
    s_waitcnt lgkmcnt(0)
    s_waitcnt lgkmcnt(0)
    s_barrier
    s_add_u32 m0, s36, 131072
    s_add_u32 s31, s32, s33
    buffer_load_dwordx4 v2, s[16:19], s31 offen offset:0 sc1 lds
    buffer_load_dwordx4 v2, s[16:19], s31 offen offset:1024 sc1 lds
    buffer_load_dwordx4 v2, s[16:19], s31 offen offset:2048 sc1 lds
    buffer_load_dwordx4 v2, s[16:19], s31 offen offset:3072 sc1 lds
    s_add_u32 s33, s33, 16384
    s_and_b32 s33, s33, 0x3ffff
    s_add_u32 s30, s27, 6
    s_bitcmp1_b32 s30, 2
    s_cselect_b32 s8, s42, s40
    s_cselect_b32 s9, s43, s41
    s_and_b32 s29, s30, 3
    s_lshl_b32 s29, s29, 19
    s_add_u32 s29, s29, 0x10000
    s_add_u32 m0, s36, 0
    s_add_u32 s29, s29, s34
    buffer_load_dwordx4 v16, s[8:11], s29 offen offset:0 lds
    buffer_load_dwordx4 v17, s[8:11], s29 offen offset:1024 lds
    buffer_load_dwordx4 v18, s[8:11], s29 offen offset:2048 lds
    buffer_load_dwordx4 v19, s[8:11], s29 offen offset:3072 lds
    s_add_u32 s30, s27, 7
    s_bitcmp1_b32 s30, 2
    s_cselect_b32 s8, s42, s40
    s_cselect_b32 s9, s43, s41
    s_and_b32 s29, s30, 3
    s_lshl_b32 s29, s29, 19
    s_add_u32 s29, s29, 0x10000
    s_add_u32 m0, s36, 16384
    s_add_u32 s29, s29, s34
    buffer_load_dwordx4 v16, s[8:11], s29 offen offset:0 lds
    buffer_load_dwordx4 v17, s[8:11], s29 offen offset:1024 lds
    buffer_load_dwordx4 v18, s[8:11], s29 offen offset:2048 lds
    buffer_load_dwordx4 v19, s[8:11], s29 offen offset:3072 lds
    s_waitcnt vmcnt(12)
    ds_read_b64_tr_b16 v[144:145], v24 offset:32768
    s_waitcnt lgkmcnt(0)
    ds_read_b64_tr_b16 v[146:147], v24 offset:33792
    s_waitcnt lgkmcnt(0)
    ds_read_b64_tr_b16 v[148:149], v25 offset:32768
    s_waitcnt lgkmcnt(0)
    ds_read_b64_tr_b16 v[150:151], v25 offset:33792
    s_waitcnt lgkmcnt(0)
    ds_read_b64_tr_b16 v[152:153], v26 offset:32768
    s_waitcnt lgkmcnt(0)
    ds_read_b64_tr_b16 v[154:155], v26 offset:33792
    s_waitcnt lgkmcnt(0)
    ds_read_b64_tr_b16 v[156:157], v27 offset:32768
    s_waitcnt lgkmcnt(0)
    ds_read_b64_tr_b16 v[158:159], v27 offset:33792
    s_waitcnt lgkmcnt(0)
    s_waitcnt lgkmcnt(0)
    ds_read_b64_tr_b16 v[160:161], v24 offset:49152
    s_waitcnt lgkmcnt(0)
    ds_read_b64_tr_b16 v[162:163], v24 offset:50176
    s_waitcnt lgkmcnt(0)
    ds_read_b64_tr_b16 v[164:165], v25 offset:49152
    s_waitcnt lgkmcnt(0)
    ds_read_b64_tr_b16 v[166:167], v25 offset:50176
    s_waitcnt lgkmcnt(0)
    ds_read_b64_tr_b16 v[168:169], v26 offset:49152
    s_waitcnt lgkmcnt(0)
    ds_read_b64_tr_b16 v[170:171], v26 offset:50176
    s_waitcnt lgkmcnt(0)
    ds_read_b64_tr_b16 v[172:173], v27 offset:49152
    s_waitcnt lgkmcnt(0)
    ds_read_b64_tr_b16 v[174:175], v27 offset:50176
    s_waitcnt lgkmcnt(0)
    s_waitcnt lgkmcnt(0)
    s_barrier
    s_add_u32 m0, s36, 147456
    s_add_u32 s31, s32, s33
    buffer_load_dwordx4 v2, s[16:19], s31 offen offset:0 sc1 lds
    buffer_load_dwordx4 v2, s[16:19], s31 offen offset:1024 sc1 lds
    buffer_load_dwordx4 v2, s[16:19], s31 offen offset:2048 sc1 lds
    buffer_load_dwordx4 v2, s[16:19], s31 offen offset:3072 sc1 lds
    s_add_u32 s33, s33, 16384
    s_and_b32 s33, s33, 0x3ffff
    s_add_u32 s30, s27, 4
    s_bitcmp1_b32 s30, 2
    s_cselect_b32 s8, s42, s40
    s_cselect_b32 s9, s43, s41
    s_and_b32 s29, s30, 3
    s_lshl_b32 s29, s29, 19
    s_add_u32 m0, s36, 32768
    s_add_u32 s29, s29, s34
    buffer_load_dwordx4 v16, s[8:11], s29 offen offset:0 lds
    buffer_load_dwordx4 v17, s[8:11], s29 offen offset:1024 lds
    buffer_load_dwordx4 v18, s[8:11], s29 offen offset:2048 lds
    buffer_load_dwordx4 v19, s[8:11], s29 offen offset:3072 lds
    s_add_u32 s30, s27, 5
    s_bitcmp1_b32 s30, 2
    s_cselect_b32 s8, s42, s40
    s_cselect_b32 s9, s43, s41
    s_and_b32 s29, s30, 3
    s_lshl_b32 s29, s29, 19
    s_add_u32 m0, s36, 49152
    s_add_u32 s29, s29, s34
    buffer_load_dwordx4 v16, s[8:11], s29 offen offset:0 lds
    buffer_load_dwordx4 v17, s[8:11], s29 offen offset:1024 lds
    buffer_load_dwordx4 v18, s[8:11], s29 offen offset:2048 lds
    buffer_load_dwordx4 v19, s[8:11], s29 offen offset:3072 lds
    s_waitcnt vmcnt(12)
    ds_read_b64_tr_b16 a[0:1], v24 offset:0
    s_waitcnt lgkmcnt(0)
    ds_read_b64_tr_b16 a[2:3], v24 offset:1024
    s_waitcnt lgkmcnt(0)
    ds_read_b64_tr_b16 a[4:5], v25 offset:0
    s_waitcnt lgkmcnt(0)
    ds_read_b64_tr_b16 a[6:7], v25 offset:1024
    s_waitcnt lgkmcnt(0)
    ds_read_b64_tr_b16 a[8:9], v26 offset:0
    s_waitcnt lgkmcnt(0)
    ds_read_b64_tr_b16 a[10:11], v26 offset:1024
    s_waitcnt lgkmcnt(0)
    ds_read_b64_tr_b16 a[12:13], v27 offset:0
    s_waitcnt lgkmcnt(0)
    ds_read_b64_tr_b16 a[14:15], v27 offset:1024
    s_waitcnt lgkmcnt(0)
    s_waitcnt lgkmcnt(0)
    ds_read_b64_tr_b16 a[16:17], v24 offset:16384
    s_waitcnt lgkmcnt(0)
    ds_read_b64_tr_b16 a[18:19], v24 offset:17408
    s_waitcnt lgkmcnt(0)
    ds_read_b64_tr_b16 a[20:21], v25 offset:16384
    s_waitcnt lgkmcnt(0)
    ds_read_b64_tr_b16 a[22:23], v25 offset:17408
    s_waitcnt lgkmcnt(0)
    ds_read_b64_tr_b16 a[24:25], v26 offset:16384
    s_waitcnt lgkmcnt(0)
    ds_read_b64_tr_b16 a[26:27], v26 offset:17408
    s_waitcnt lgkmcnt(0)
    ds_read_b64_tr_b16 a[28:29], v27 offset:16384
    s_waitcnt lgkmcnt(0)
    ds_read_b64_tr_b16 a[30:31], v27 offset:17408
    s_waitcnt lgkmcnt(0)
    s_waitcnt lgkmcnt(0)
    s_barrier
    s_add_u32 m0, s36, 98304
    s_add_u32 s31, s32, s33
    buffer_load_dwordx4 v2, s[16:19], s31 offen offset:0 sc1 lds
    buffer_load_dwordx4 v2, s[16:19], s31 offen offset:1024 sc1 lds
    buffer_load_dwordx4 v2, s[16:19], s31 offen offset:2048 sc1 lds
    buffer_load_dwordx4 v2, s[16:19], s31 offen offset:3072 sc1 lds
    s_add_u32 s33, s33, 16384
    s_and_b32 s33, s33, 0x3ffff
    s_add_u32 s30, s27, 0
    s_bitcmp1_b32 s30, 2
    s_cselect_b32 s8, s42, s40
    s_cselect_b32 s9, s43, s41
    s_and_b32 s29, s30, 3
    s_lshl_b32 s29, s29, 19
    s_add_u32 m0, s36, 0
    s_add_u32 s29, s29, s34
    buffer_load_dwordx4 v16, s[8:11], s29 offen offset:0 lds
    buffer_load_dwordx4 v17, s[8:11], s29 offen offset:1024 lds
    buffer_load_dwordx4 v18, s[8:11], s29 offen offset:2048 lds
    buffer_load_dwordx4 v19, s[8:11], s29 offen offset:3072 lds
    s_add_u32 s30, s27, 1
    s_bitcmp1_b32 s30, 2
    s_cselect_b32 s8, s42, s40
    s_cselect_b32 s9, s43, s41
    s_and_b32 s29, s30, 3
    s_lshl_b32 s29, s29, 19
    s_add_u32 m0, s36, 16384
    s_add_u32 s29, s29, s34
    buffer_load_dwordx4 v16, s[8:11], s29 offen offset:0 lds
    buffer_load_dwordx4 v17, s[8:11], s29 offen offset:1024 lds
    buffer_load_dwordx4 v18, s[8:11], s29 offen offset:2048 lds
    buffer_load_dwordx4 v19, s[8:11], s29 offen offset:3072 lds
    s_waitcnt vmcnt(12)
    ds_read_b64_tr_b16 a[32:33], v24 offset:32768
    s_waitcnt lgkmcnt(0)
    ds_read_b64_tr_b16 a[34:35], v24 offset:33792
    s_waitcnt lgkmcnt(0)
    ds_read_b64_tr_b16 a[36:37], v25 offset:32768
    s_waitcnt lgkmcnt(0)
    ds_read_b64_tr_b16 a[38:39], v25 offset:33792
    s_waitcnt lgkmcnt(0)
    ds_read_b64_tr_b16 a[40:41], v26 offset:32768
    s_waitcnt lgkmcnt(0)
    ds_read_b64_tr_b16 a[42:43], v26 offset:33792
    s_waitcnt lgkmcnt(0)
    ds_read_b64_tr_b16 a[44:45], v27 offset:32768
    s_waitcnt lgkmcnt(0)
    ds_read_b64_tr_b16 a[46:47], v27 offset:33792
    s_waitcnt lgkmcnt(0)
    s_waitcnt lgkmcnt(0)
    ds_write_b128 v14, a[32:35] offset:0
    s_waitcnt lgkmcnt(0)
    ds_write_b128 v14, a[36:39] offset:1024
    s_waitcnt lgkmcnt(0)
    ds_write_b128 v14, a[40:43] offset:2048
    s_waitcnt lgkmcnt(0)
    ds_write_b128 v14, a[44:47] offset:3072
    s_waitcnt lgkmcnt(0)
    ds_read_b64_tr_b16 a[48:49], v24 offset:49152
    s_waitcnt lgkmcnt(0)
    ds_read_b64_tr_b16 a[50:51], v24 offset:50176
    s_waitcnt lgkmcnt(0)
    ds_read_b64_tr_b16 a[52:53], v25 offset:49152
    s_waitcnt lgkmcnt(0)
    ds_read_b64_tr_b16 a[54:55], v25 offset:50176
    s_waitcnt lgkmcnt(0)
    ds_read_b64_tr_b16 a[56:57], v26 offset:49152
    s_waitcnt lgkmcnt(0)
    ds_read_b64_tr_b16 a[58:59], v26 offset:50176
    s_waitcnt lgkmcnt(0)
    ds_read_b64_tr_b16 a[60:61], v27 offset:49152
    s_waitcnt lgkmcnt(0)
    ds_read_b64_tr_b16 a[62:63], v27 offset:50176
    s_waitcnt lgkmcnt(0)
    s_waitcnt lgkmcnt(0)
    ds_write_b128 v14, a[48:51] offset:16384
    s_waitcnt lgkmcnt(0)
    ds_write_b128 v14, a[52:55] offset:17408
    s_waitcnt lgkmcnt(0)
    ds_write_b128 v14, a[56:59] offset:18432
    s_waitcnt lgkmcnt(0)
    ds_write_b128 v14, a[60:63] offset:19456
    s_waitcnt lgkmcnt(0)
    s_barrier
    s_add_u32 m0, s36, 114688
    s_add_u32 s31, s32, s33
    buffer_load_dwordx4 v2, s[16:19], s31 offen offset:0 sc1 lds
    buffer_load_dwordx4 v2, s[16:19], s31 offen offset:1024 sc1 lds
    buffer_load_dwordx4 v2, s[16:19], s31 offen offset:2048 sc1 lds
    buffer_load_dwordx4 v2, s[16:19], s31 offen offset:3072 sc1 lds
    s_add_u32 s33, s33, 16384
    s_and_b32 s33, s33, 0x3ffff
    s_add_u32 s30, s27, 2
    s_bitcmp1_b32 s30, 2
    s_cselect_b32 s8, s42, s40
    s_cselect_b32 s9, s43, s41
    s_and_b32 s29, s30, 3
    s_lshl_b32 s29, s29, 19
    s_add_u32 m0, s36, 32768
    s_add_u32 s29, s29, s34
    buffer_load_dwordx4 v16, s[8:11], s29 offen offset:0 lds
    buffer_load_dwordx4 v17, s[8:11], s29 offen offset:1024 lds
    buffer_load_dwordx4 v18, s[8:11], s29 offen offset:2048 lds
    buffer_load_dwordx4 v19, s[8:11], s29 offen offset:3072 lds
    s_add_u32 s30, s27, 3
    s_bitcmp1_b32 s30, 2
    s_cselect_b32 s8, s42, s40
    s_cselect_b32 s9, s43, s41
    s_and_b32 s29, s30, 3
    s_lshl_b32 s29, s29, 19
    s_add_u32 m0, s36, 49152
    s_add_u32 s29, s29, s34
    buffer_load_dwordx4 v16, s[8:11], s29 offen offset:0 lds
    buffer_load_dwordx4 v17, s[8:11], s29 offen offset:1024 lds
    buffer_load_dwordx4 v18, s[8:11], s29 offen offset:2048 lds
    buffer_load_dwordx4 v19, s[8:11], s29 offen offset:3072 lds
    s_waitcnt vmcnt(12)
    ds_read_b64_tr_b16 a[32:33], v24 offset:0
    s_waitcnt lgkmcnt(0)
    ds_read_b64_tr_b16 a[34:35], v24 offset:1024
    s_waitcnt lgkmcnt(0)
    ds_read_b64_tr_b16 a[36:37], v25 offset:0
    s_waitcnt lgkmcnt(0)
    ds_read_b64_tr_b16 a[38:39], v25 offset:1024
    s_waitcnt lgkmcnt(0)
    ds_read_b64_tr_b16 a[40:41], v26 offset:0
    s_waitcnt lgkmcnt(0)
    ds_read_b64_tr_b16 a[42:43], v26 offset:1024
    s_waitcnt lgkmcnt(0)
    ds_read_b64_tr_b16 a[44:45], v27 offset:0
    s_waitcnt lgkmcnt(0)
    ds_read_b64_tr_b16 a[46:47], v27 offset:1024
    s_waitcnt lgkmcnt(0)
    s_waitcnt lgkmcnt(0)
    ds_write_b128 v13, a[32:35] offset:0
    s_waitcnt lgkmcnt(0)
    ds_write_b128 v13, a[36:39] offset:1024
    s_waitcnt lgkmcnt(0)
    ds_write_b128 v13, a[40:43] offset:2048
    s_waitcnt lgkmcnt(0)
    ds_write_b128 v13, a[44:47] offset:3072
    s_waitcnt lgkmcnt(0)
    ds_read_b64_tr_b16 a[48:49], v24 offset:16384
    s_waitcnt lgkmcnt(0)
    ds_read_b64_tr_b16 a[50:51], v24 offset:17408
    s_waitcnt lgkmcnt(0)
    ds_read_b64_tr_b16 a[52:53], v25 offset:16384
    s_waitcnt lgkmcnt(0)
    ds_read_b64_tr_b16 a[54:55], v25 offset:17408
    s_waitcnt lgkmcnt(0)
    ds_read_b64_tr_b16 a[56:57], v26 offset:16384
    s_waitcnt lgkmcnt(0)
    ds_read_b64_tr_b16 a[58:59], v26 offset:17408
    s_waitcnt lgkmcnt(0)
    ds_read_b64_tr_b16 a[60:61], v27 offset:16384
    s_waitcnt lgkmcnt(0)
    ds_read_b64_tr_b16 a[62:63], v27 offset:17408
    s_waitcnt lgkmcnt(0)
    s_waitcnt lgkmcnt(0)
    ds_write_b128 v13, a[48:51] offset:16384
    s_waitcnt lgkmcnt(0)
    ds_write_b128 v13, a[52:55] offset:17408
    s_waitcnt lgkmcnt(0)
    ds_write_b128 v13, a[56:59] offset:18432
    s_waitcnt lgkmcnt(0)
    ds_write_b128 v13, a[60:63] offset:19456
    s_waitcnt lgkmcnt(0)
    s_barrier
    s_add_u32 m0, s36, 131072
    s_add_u32 s31, s32, s33
    buffer_load_dwordx4 v2, s[16:19], s31 offen offset:0 sc1 lds
    buffer_load_dwordx4 v2, s[16:19], s31 offen offset:1024 sc1 lds
    buffer_load_dwordx4 v2, s[16:19], s31 offen offset:2048 sc1 lds
    buffer_load_dwordx4 v2, s[16:19], s31 offen offset:3072 sc1 lds
    s_add_u32 s33, s33, 16384
    s_and_b32 s33, s33, 0x3ffff
    s_waitcnt vmcnt(4)
    ds_read_b64_tr_b16 a[32:33], v24 offset:32768
    s_waitcnt lgkmcnt(0)
    ds_read_b64_tr_b16 a[34:35], v24 offset:33792
    s_waitcnt lgkmcnt(0)
    ds_read_b64_tr_b16 a[36:37], v25 offset:32768
    s_waitcnt lgkmcnt(0)
    ds_read_b64_tr_b16 a[38:39], v25 offset:33792
    s_waitcnt lgkmcnt(0)
    ds_read_b64_tr_b16 a[40:41], v26 offset:32768
    s_waitcnt lgkmcnt(0)
    ds_read_b64_tr_b16 a[42:43], v26 offset:33792
    s_waitcnt lgkmcnt(0)
    ds_read_b64_tr_b16 a[44:45], v27 offset:32768
    s_waitcnt lgkmcnt(0)
    ds_read_b64_tr_b16 a[46:47], v27 offset:33792
    s_waitcnt lgkmcnt(0)
    s_waitcnt lgkmcnt(0)
    ds_write_b128 v13, a[32:35] offset:32768
    s_waitcnt lgkmcnt(0)
    ds_write_b128 v13, a[36:39] offset:33792
    s_waitcnt lgkmcnt(0)
    ds_write_b128 v13, a[40:43] offset:34816
    s_waitcnt lgkmcnt(0)
    ds_write_b128 v13, a[44:47] offset:35840
    s_waitcnt lgkmcnt(0)
    ds_read_b64_tr_b16 a[48:49], v24 offset:49152
    s_waitcnt lgkmcnt(0)
    ds_read_b64_tr_b16 a[50:51], v24 offset:50176
    s_waitcnt lgkmcnt(0)
    ds_read_b64_tr_b16 a[52:53], v25 offset:49152
    s_waitcnt lgkmcnt(0)
    ds_read_b64_tr_b16 a[54:55], v25 offset:50176
    s_waitcnt lgkmcnt(0)
    ds_read_b64_tr_b16 a[56:57], v26 offset:49152
    s_waitcnt lgkmcnt(0)
    ds_read_b64_tr_b16 a[58:59], v26 offset:50176
    s_waitcnt lgkmcnt(0)
    ds_read_b64_tr_b16 a[60:61], v27 offset:49152
    s_waitcnt lgkmcnt(0)
    ds_read_b64_tr_b16 a[62:63], v27 offset:50176
    s_waitcnt lgkmcnt(0)
    s_waitcnt lgkmcnt(0)
    ds_write_b128 v13, a[48:51] offset:49152
    s_waitcnt lgkmcnt(0)
    ds_write_b128 v13, a[52:55] offset:50176
    s_waitcnt lgkmcnt(0)
    ds_write_b128 v13, a[56:59] offset:51200
    s_waitcnt lgkmcnt(0)
    ds_write_b128 v13, a[60:63] offset:52224
    s_waitcnt lgkmcnt(0)
    s_barrier
    s_add_u32 m0, s36, 147456
    s_add_u32 s31, s32, s33
    buffer_load_dwordx4 v2, s[16:19], s31 offen offset:0 sc1 lds
    buffer_load_dwordx4 v2, s[16:19], s31 offen offset:1024 sc1 lds
    buffer_load_dwordx4 v2, s[16:19], s31 offen offset:2048 sc1 lds
    buffer_load_dwordx4 v2, s[16:19], s31 offen offset:3072 sc1 lds
    s_add_u32 s33, s33, 16384
    s_and_b32 s33, s33, 0x3ffff
    s_barrier
    s_add_u32 m0, s36, 98304
    s_add_u32 s31, s32, s33
    buffer_load_dwordx4 v2, s[16:19], s31 offen offset:0 sc1 lds
    buffer_load_dwordx4 v2, s[16:19], s31 offen offset:1024 sc1 lds
    buffer_load_dwordx4 v2, s[16:19], s31 offen offset:2048 sc1 lds
    buffer_load_dwordx4 v2, s[16:19], s31 offen offset:3072 sc1 lds
    s_add_u32 s33, s33, 16384
    s_and_b32 s33, s33, 0x3ffff
    s_waitcnt vmcnt(0)
    s_barrier
    s_add_u32 m0, s36, 114688
    s_add_u32 s31, s32, s33
    buffer_load_dwordx4 v2, s[16:19], s31 offen offset:0 sc1 lds
    buffer_load_dwordx4 v2, s[16:19], s31 offen offset:1024 sc1 lds
    buffer_load_dwordx4 v2, s[16:19], s31 offen offset:2048 sc1 lds
    buffer_load_dwordx4 v2, s[16:19], s31 offen offset:3072 sc1 lds
    s_add_u32 s33, s33, 16384
    s_and_b32 s33, s33, 0x3ffff
    s_waitcnt vmcnt(0)
    s_barrier
    s_waitcnt vmcnt(0) lgkmcnt(0)
    s_cmp_lg_u32 s24, 0
    s_cbranch_scc1 H_NOPOLL2
    s_setprio 3
    s_sleep 64
    s_mov_b32 s30, 0x40000
POLL_O:
    buffer_load_dword v10, v9, s[16:19], s44 offen sc1
    s_waitcnt vmcnt(0)
    v_cmp_lt_u32 vcc, v10, v11
    s_sub_u32 s30, s30, 1
    s_cbranch_scc1 POLLD_O
    s_cbranch_vccz POLLD_O
    s_sleep 8
    s_branch POLL_O
POLLD_O:
    s_add_u32 s29, s46, 0
    buffer_load_dword v20, v12, s[16:19], s29 offen sc1
    s_add_u32 s29, s46, 131072
    buffer_load_dword v21, v12, s[16:19], s29 offen sc1
    s_add_u32 s29, s46, 262144
    buffer_load_dword v22, v12, s[16:19], s29 offen sc1
    s_add_u32 s29, s46, 393216
    buffer_load_dword v23, v12, s[16:19], s29 offen sc1
H_NOPOLL2:
    s_barrier
    ds_write_b128 v15, v[48:51] offset:0
    ds_write_b128 v15, v[52:55] offset:1024
    ds_write_b128 v15, v[56:59] offset:2048
    ds_write_b128 v15, v[60:63] offset:3072
    ds_write_b128 v15, v[64:67] offset:16384
    ds_write_b128 v15, v[68:71] offset:17408
    ds_write_b128 v15, v[72:75] offset:18432
    ds_write_b128 v15, v[76:79] offset:19456
    ds_write_b128 v15, v[80:83] offset:32768
    ds_write_b128 v15, v[84:87] offset:33792
    ds_write_b128 v15, v[88:91] offset:34816
    ds_write_b128 v15, v[92:95] offset:35840
    s_waitcnt lgkmcnt(8)
    ds_write_b128 v15, v[96:99] offset:49152
    ds_write_b128 v15, v[100:103] offset:50176
    ds_write_b128 v15, v[104:107] offset:51200
    ds_write_b128 v15, v[108:111] offset:52224
    s_barrier
    s_waitcnt lgkmcnt(0)
    s_barrier
    ds_write_b128 v13, v[112:115] offset:0
    s_waitcnt lgkmcnt(0)
    ds_write_b128 v13, v[116:119] offset:1024
    s_waitcnt lgkmcnt(0)
    ds_write_b128 v13, v[120:123] offset:2048
    s_waitcnt lgkmcnt(0)
    ds_write_b128 v13, v[124:127] offset:3072
    s_waitcnt lgkmcnt(0)
    ds_write_b128 v13, v[128:131] offset:16384
    s_waitcnt lgkmcnt(0)
    ds_write_b128 v13, v[132:135] offset:17408
    s_waitcnt lgkmcnt(0)
    ds_write_b128 v13, v[136:139] offset:18432
    s_waitcnt lgkmcnt(0)
    ds_write_b128 v13, v[140:143] offset:19456
    s_waitcnt lgkmcnt(0)
    s_waitcnt lgkmcnt(0)
    s_barrier
    ds_write_b128 v13, v[144:147] offset:32768
    s_waitcnt lgkmcnt(0)
    ds_write_b128 v13, v[148:151] offset:33792
    s_waitcnt lgkmcnt(0)
    ds_write_b128 v13, v[152:155] offset:34816
    s_waitcnt lgkmcnt(0)
    ds_write_b128 v13, v[156:159] offset:35840
    s_waitcnt lgkmcnt(0)
    ds_write_b128 v13, v[160:163] offset:49152
    s_waitcnt lgkmcnt(0)
    ds_write_b128 v13, v[164:167] offset:50176
    s_waitcnt lgkmcnt(0)
    ds_write_b128 v13, v[168:171] offset:51200
    s_waitcnt lgkmcnt(0)
    ds_write_b128 v13, v[172:175] offset:52224
    s_waitcnt lgkmcnt(0)
    s_cmp_lg_u32 s24, 0
    s_cbranch_scc1 H_NOPOLL3
    s_mov_b32 s30, 0x40000
POLL_O2:
    buffer_load_dword v10, v9, s[16:19], s44 offen offset:128 sc1
    s_waitcnt vmcnt(0)
    v_cmp_lt_u32 vcc, v10, v11
    s_sub_u32 s30, s30, 1
    s_cbranch_scc1 POLLD_O2
    s_cbranch_vccz POLLD_O2
    s_sleep 2
    s_branch POLL_O2
POLLD_O2:
H_NOPOLL3:
    s_waitcnt lgkmcnt(0)
    s_barrier
    ds_write_b128 v14, a[0:3] offset:0
    s_waitcnt lgkmcnt(0)
    ds_write_b128 v14, a[4:7] offset:1024
    s_waitcnt lgkmcnt(0)
    ds_write_b128 v14, a[8:11] offset:2048
    s_waitcnt lgkmcnt(0)
    ds_write_b128 v14, a[12:15] offset:3072
    s_waitcnt lgkmcnt(0)
    ds_write_b128 v14, a[16:19] offset:16384
    s_waitcnt lgkmcnt(0)
    ds_write_b128 v14, a[20:23] offset:17408
    s_waitcnt lgkmcnt(0)
    ds_write_b128 v14, a[24:27] offset:18432
    s_waitcnt lgkmcnt(0)
    ds_write_b128 v14, a[28:31] offset:19456
    s_waitcnt lgkmcnt(0)
    s_endpgm
COMPUTE:
    v_lshlrev_b32 v3, 7, v1
    s_and_b32 s30, s2, 0xfe
    s_add_u32 s30, s30, s24
    s_lshl_b32 s30, s30, 13
    s_lshr_b32 s29, s24, 1
    s_andn2_b32 s29, s2, s29
    s_bitcmp1_b32 s29, 0
    s_cselect_b32 s30, s30, 0x40000000
    s_lshl_b32 s29, s24, 10
    s_and_b32 s29, s29, 1024
    s_add_u32 m0, s29, 131072
    s_waitcnt lgkmcnt(0)
    s_mov_b32 s20, s54
    s_and_b32 s21, s55, 0xffff
    s_mov_b32 s22, 0x800
    s_mov_b32 s23, 0x20000
    buffer_load_dwordx4 v2, s[20:23], s29 offen lds
    s_mov_b32 s8, s42
    s_and_b32 s9, s43, 0xffff
    s_mov_b32 s10, 0x200000
    s_mov_b32 s11, 0x20000
    s_mov_b32 s16, s60
    s_and_b32 s17, s61, 0xffff
    s_mov_b32 s18, 0x900000
    s_mov_b32 s19, 0x20000
    s_lshl_b32 s55, s25, 8
    s_add_u32 s55, s55, 589824
    s_lshl_b32 s29, s26, 2
    s_add_u32 s29, s29, s24
    s_cmp_eq_u32 s29, 3
    s_cselect_b32 s29, s55, 0x40000000
    v_lshlrev_b32 v8, 2, v1
    v_mov_b32 v9, 0
    buffer_store_dword v9, v8, s[16:19], s29 offen sc1
    buffer_load_dword v0, v3, s[8:11], s30 offen
    v_and_b32 v8, 15, v1
    s_and_b32 s29, s24, 1
    s_lshl_b32 s29, s29, 4
    v_add_u32 v8, s29, v8
    v_lshrrev_b32 v9, 4, v1
    v_bfe_u32 v10, v8, 1, 3
    v_xor_b32 v10, v10, v9
    v_lshlrev_b32 v8, 7, v8
    v_lshl_add_u32 v144, v10, 4, v8
    v_xor_b32 v10, 4, v10
    v_lshl_add_u32 v145, v10, 4, v8
    v_bfe_u32 v11, v1, 2, 2
    v_and_b32 v14, 3, v1
    v_lshl_add_u32 v12, v9, 3, v11
    v_lshlrev_b32 v12, 6, v12
    v_lshl_add_u32 v12, v14, 3, v12
    s_lshr_b32 s29, s24, 1
    s_lshl_b32 s29, s29, 5
    v_add_u32 v146, s29, v12
    v_lshlrev_b32 v148, 4, v9
    v_add_u32 v148, 131072, v148
    s_lshl_b32 s29, s28, 8
    v_add_u32 v147, s29, v148
    v_mov_b32 v152, 0
    v_mov_b32 v153, 0
    v_mov_b32 v154, 0
    v_mov_b32 v155, 0
    v_mov_b32 v156, 0
    v_mov_b32 v157, 0
    v_mov_b32 v158, 0
    v_mov_b32 v159, 0
    v_mov_b32 v160, 0
    v_mov_b32 v161, 0
    v_mov_b32 v162, 0
    v_mov_b32 v163, 0
    v_and_b32 v8, 15, v1
    v_bfe_u32 v9, v1, 4, 1
    v_lshrrev_b32 v10, 5, v1
    v_lshl_add_u32 v13, v10, 5, v8
    v_lshlrev_b32 v13, 4, v13
    v_lshl_add_u32 v12, v9, 10, v13
    v_lshl_add_u32 v13, v9, 3, v13
    s_and_b32 s29, s24, 1
    s_lshr_b32 s30, s24, 1
    s_lshl_b32 s31, s29, 8
    s_lshl_b32 s32, s30, 3
    s_add_u32 s31, s31, s32
    v_add_u32 v149, s31, v12
    s_lshl_b32 s31, s29, 10
    s_lshl_b32 s32, s30, 8
    s_add_u32 s31, s31, s32
    v_add_u32 v150, s31, v13
    v_lshlrev_b32 v151, 2, v1
    v_and_b32 v15, 15, v1
    v_lshrrev_b32 v9, 4, v1
    v_bfe_u32 v10, v1, 1, 3
    v_xor_b32 v10, v10, v9
    v_lshlrev_b32 v15, 7, v15
    s_and_b32 s29, s24, 1
    s_lshl_b32 s29, s29, 13
    v_add_u32 v15, s29, v15
    v_lshl_add_u32 v7, v10, 4, v15
    v_xor_b32 v8, 64, v7
    v_lshl_add_u32 v12, v9, 3, v11
    v_and_b32 v13, 1, v9
    v_lshl_add_u32 v13, v11, 1, v13
    s_and_b32 s30, s24, 2
    s_lshl_b32 s30, s30, 1
    v_xor_b32 v13, s30, v13
    v_lshlrev_b32 v13, 5, v13
    v_lshl_add_u32 v13, v14, 3, v13
    v_lshl_add_u32 v3, v12, 8, v13
    v_xor_b32 v4, 32, v3
    v_xor_b32 v5, 64, v3
    v_xor_b32 v6, 96, v3
    v_mov_b32 v16, 0
    v_mov_b32 v17, 0
    v_mov_b32 v18, 0
    v_mov_b32 v19, 0
    v_mov_b32 v20, 0
    v_mov_b32 v21, 0
    v_mov_b32 v22, 0
    v_mov_b32 v23, 0
    v_mov_b32 v24, 0
    v_mov_b32 v25, 0
    v_mov_b32 v26, 0
    v_mov_b32 v27, 0
    v_mov_b32 v28, 0
    v_mov_b32 v29, 0
    v_mov_b32 v30, 0
    v_mov_b32 v31, 0
    v_mov_b32 v32, 0
    v_mov_b32 v33, 0
    v_mov_b32 v34, 0
    v_mov_b32 v35, 0
    v_mov_b32 v36, 0
    v_mov_b32 v37, 0
    v_mov_b32 v38, 0
    v_mov_b32 v39, 0
    v_mov_b32 v40, 0
    v_mov_b32 v41, 0
    v_mov_b32 v42, 0
    v_mov_b32 v43, 0
    v_mov_b32 v44, 0
    v_mov_b32 v45, 0
    v_mov_b32 v46, 0
    v_mov_b32 v47, 0
    v_mov_b32 v48, 0
    v_mov_b32 v49, 0
    v_mov_b32 v50, 0
    v_mov_b32 v51, 0
    v_mov_b32 v52, 0
    v_mov_b32 v53, 0
    v_mov_b32 v54, 0
    v_mov_b32 v55, 0
    v_mov_b32 v56, 0
    v_mov_b32 v57, 0
    v_mov_b32 v58, 0
    v_mov_b32 v59, 0
    v_mov_b32 v60, 0
    v_mov_b32 v61, 0
    v_mov_b32 v62, 0
    v_mov_b32 v63, 0
    v_mov_b32 v64, 0
    v_mov_b32 v65, 0
    v_mov_b32 v66, 0
    v_mov_b32 v67, 0
    v_mov_b32 v68, 0
    v_mov_b32 v69, 0
    v_mov_b32 v70, 0
    v_mov_b32 v71, 0
    v_mov_b32 v72, 0
    v_mov_b32 v73, 0
    v_mov_b32 v74, 0
    v_mov_b32 v75, 0
    v_mov_b32 v76, 0
    v_mov_b32 v77, 0
    v_mov_b32 v78, 0
    v_mov_b32 v79, 0
    v_accvgpr_write_b32 a0, 0
    v_accvgpr_write_b32 a1, 0
    v_accvgpr_write_b32 a2, 0
    v_accvgpr_write_b32 a3, 0
    v_accvgpr_write_b32 a4, 0
    v_accvgpr_write_b32 a5, 0
    v_accvgpr_write_b32 a6, 0
    v_accvgpr_write_b32 a7, 0
    v_accvgpr_write_b32 a8, 0
    v_accvgpr_write_b32 a9, 0
    v_accvgpr_write_b32 a10, 0
    v_accvgpr_write_b32 a11, 0
    v_accvgpr_write_b32 a12, 0
    v_accvgpr_write_b32 a13, 0
    v_accvgpr_write_b32 a14, 0
    v_accvgpr_write_b32 a15, 0
    v_accvgpr_write_b32 a60, 0
    v_accvgpr_write_b32 a61, 0
    v_accvgpr_write_b32 a62, 0
    v_accvgpr_write_b32 a63, 0
    v_mov_b32 v15, 0x3f803f80
    v_and_b32 v14, 7, v1
    v_cmp_eq_u32 vcc, 0, v14
    v_cmp_eq_u32 s[46:47], 4, v14
    v_mov_b32 v9, 0xdddddddd
    s_nop 0
    v_cndmask_b32 v12, 0, v15, vcc
    v_cndmask_b32 v13, 0, v15, vcc
    v_cndmask_b32 v14, 0, v15, s[46:47]
    v_cndmask_b32 v15, 0, v15, s[46:47]
    s_bfe_u32 s32, s26, 0x10002
    s_lshl_b32 s37, s32, 31
    s_lshl_b32 s31, s32, 13
    s_lshl_b32 s32, s32, 18
    s_lshl_b32 s30, s25, 2
    s_and_b32 s29, s26, 3
    s_add_u32 s30, s30, s29
    s_lshl_b32 s35, s30, 12
    s_add_u32 s35, s35, s32
    s_lshl_b32 s36, s30, 7
    s_add_u32 s36, s36, s31
    s_and_b32 s31, s24, 1
    s_lshl_b32 s31, s31, 6
    s_add_u32 s36, s36, s31
    s_add_u32 s36, s36, 524288
    s_cmp_lt_u32 s24, 2
    s_cselect_b32 s36, s36, 0x40000000
    s_xor_b32 s37, s37, 0xbfb8aa3b
    s_lshr_b32 s32, s26, 3
    s_lshl_b32 s32, s32, 18
    s_mov_b32 s39, 32768
    s_cmp_eq_u32 s24, 3
    s_cselect_b32 s45, 0x2804, 0
    s_lshl_b32 s29, s25, 2
    s_and_b32 s30, s24, 1
    s_lshl_b32 s30, s30, 1
    s_add_u32 s29, s29, s30
    s_lshl_b32 s48, s29, 7
    s_lshr_b32 s30, s32, 5
    s_add_u32 s48, s48, s30
    s_add_u32 s48, s48, 524288
    s_lshl_b32 s50, s29, 17
    s_lshl_b32 s31, s26, 2
    s_and_b32 s29, s24, 2
    s_add_u32 s31, s31, s29
    s_lshl_b32 s31, s31, 10
    s_add_u32 s50, s50, s31
    s_add_u32 s50, s50, 1048576
    s_add_u32 s51, s50, 0x20000
    s_add_u32 s52, s50, 0x10000
    s_add_u32 s53, s51, 0x10000
    s_mov_b32 s33, 32768
    s_lshl_b32 s84, s25, 2
    s_add_u32 s84, s84, s24
    s_lshl_b32 s85, s84, 17
    s_add_u32 s85, s85, 1048576
    s_bfe_u32 s29, s2, 0x20001
    s_lshr_b32 s86, s26, 3
    s_lshl_b32 s86, s86, 2
    s_add_u32 s86, s86, s29
    s_lshl_b32 s86, s86, 13
    s_add_u32 s87, s85, s86
    s_add_u32 s88, s87, 4096
    s_mov_b32 s38, 0
    s_waitcnt vmcnt(2)
    s_barrier
    s_bitcmp1_b32 s2, 0
    s_cbranch_scc1 P1_Q0
    ds_read_b64_tr_b16 a[16:17], v146 offset:8192
    ds_read_b64_tr_b16 a[18:19], v146 offset:8448
    ds_read_b128 a[24:27], v144 offset:0
    ds_read_b64_tr_b16 a[20:21], v146 offset:16384
    ds_read_b64_tr_b16 a[22:23], v146 offset:16640
    ds_read_b128 a[28:31], v147 offset:0
    ds_read_b64_tr_b16 a[32:33], v146 offset:10240
    ds_read_b64_tr_b16 a[34:35], v146 offset:10496
    ds_read_b128 a[40:43], v145 offset:0
    ds_read_b64_tr_b16 a[36:37], v146 offset:18432
    ds_read_b64_tr_b16 a[38:39], v146 offset:18688
    ds_read_b128 a[44:47], v147 offset:64
KV_LOOP:
    s_waitcnt lgkmcnt(6)
    v_mfma_f32_16x16x32_bf16 v[152:155], a[16:19], a[24:27], v[152:155]
    v_mfma_f32_16x16x32_bf16 v[156:159], a[24:27], a[20:23], v[156:159]
    v_mfma_f32_16x16x32_bf16 v[160:163], a[28:31], a[24:27], v[160:163]
    ds_read_b64_tr_b16 a[48:49], v146 offset:12288
    ds_read_b64_tr_b16 a[50:51], v146 offset:12544
    ds_read_b128 a[56:59], v144 offset:4096
    ds_read_b64_tr_b16 a[52:53], v146 offset:20480
    ds_read_b64_tr_b16 a[54:55], v146 offset:20736
    ds_read_b128 a[60:63], v147 offset:128
    s_waitcnt lgkmcnt(6)
    v_mfma_f32_16x16x32_bf16 v[152:155], a[32:35], a[40:43], v[152:155]
    v_mfma_f32_16x16x32_bf16 v[156:159], a[40:43], a[36:39], v[156:159]
    v_mfma_f32_16x16x32_bf16 v[160:163], a[44:47], a[40:43], v[160:163]
    ds_read_b64_tr_b16 a[64:65], v146 offset:14336
    ds_read_b64_tr_b16 a[66:67], v146 offset:14592
    ds_read_b128 a[72:75], v145 offset:4096
    ds_read_b64_tr_b16 a[68:69], v146 offset:22528
    ds_read_b64_tr_b16 a[70:71], v146 offset:22784
    ds_read_b128 a[76:79], v147 offset:192
    s_and_b32 s29, s38, 3
    s_cmp_eq_u32 s29, 3
    s_cselect_b32 s29, 0xfffe8000, s39
    v_add_u32 v144, s29, v144
    v_add_u32 v145, s29, v145
    v_add_u32 v146, s29, v146
    s_add_u32 s28, s28, 1
    s_and_b32 s28, s28, 7
    s_lshl_b32 s29, s28, 8
    v_add_u32 v147, s29, v148
    s_add_u32 s38, s38, 1
    s_cmp_lt_u32 s38, 8
    s_waitcnt lgkmcnt(0)
    s_cbranch_scc0 KV_TAIL
    s_barrier
    ds_read_b64_tr_b16 a[16:17], v146 offset:8192
    ds_read_b64_tr_b16 a[18:19], v146 offset:8448
    ds_read_b128 a[24:27], v144 offset:0
    ds_read_b64_tr_b16 a[20:21], v146 offset:16384
    ds_read_b64_tr_b16 a[22:23], v146 offset:16640
    ds_read_b128 a[28:31], v147 offset:0
    v_mfma_f32_16x16x32_bf16 v[152:155], a[48:51], a[56:59], v[152:155]
    v_mfma_f32_16x16x32_bf16 v[156:159], a[56:59], a[52:55], v[156:159]
    v_mfma_f32_16x16x32_bf16 v[160:163], a[60:63], a[56:59], v[160:163]
    ds_read_b64_tr_b16 a[32:33], v146 offset:10240
    ds_read_b64_tr_b16 a[34:35], v146 offset:10496
    ds_read_b128 a[40:43], v145 offset:0
    ds_read_b64_tr_b16 a[36:37], v146 offset:18432
    ds_read_b64_tr_b16 a[38:39], v146 offset:18688
    ds_read_b128 a[44:47], v147 offset:64
    v_mfma_f32_16x16x32_bf16 v[152:155], a[64:67], a[72:75], v[152:155]
    v_mfma_f32_16x16x32_bf16 v[156:159], a[72:75], a[68:71], v[156:159]
    v_mfma_f32_16x16x32_bf16 v[160:163], a[76:79], a[72:75], v[160:163]
    s_branch KV_LOOP
KV_TAIL:
    v_mfma_f32_16x16x32_bf16 v[152:155], a[48:51], a[56:59], v[152:155]
    v_mfma_f32_16x16x32_bf16 v[156:159], a[56:59], a[52:55], v[156:159]
    v_mfma_f32_16x16x32_bf16 v[160:163], a[60:63], a[56:59], v[160:163]
    v_mfma_f32_16x16x32_bf16 v[152:155], a[64:67], a[72:75], v[152:155]
    v_mfma_f32_16x16x32_bf16 v[156:159], a[72:75], a[68:71], v[156:159]
    v_mfma_f32_16x16x32_bf16 v[160:163], a[76:79], a[72:75], v[160:163]
    v_accvgpr_write_b32 a60, 0
    v_accvgpr_write_b32 a61, 0
    v_accvgpr_write_b32 a62, 0
    v_accvgpr_write_b32 a63, 0
    s_nop 1
    s_mov_b32 s31, 0x3e8293ee
    v_mul_f32 v152, s31, v152
    v_mul_f32 v153, s31, v153
    v_mul_f32 v154, s31, v154
    v_mul_f32 v155, s31, v155
    v_mul_f32 v160, s37, v160
    v_cvt_pk_bf16_f32 v156, v156, v157
    v_exp_f32 v160, v160
    v_cvt_pk_bf16_f32 v157, v158, v159
    v_add_f32 v160, 1.0, v160
    v_cvt_pk_bf16_f32 v152, v152, v153
    v_rcp_f32 v160, v160
    v_cvt_pk_bf16_f32 v153, v154, v155
    buffer_store_dwordx2 v[156:157], v150, s[16:19], s35 offen offset:2048 sc1
    buffer_store_dwordx2 v[152:153], v149, s[16:19], s35 offen sc1
    s_mov_b64 exec, 0xffff
    buffer_store_dword v160, v151, s[16:19], s36 offen sc1
    s_mov_b64 exec, -1
    s_barrier
P1_Q0:
    ds_read_b64_tr_b16 v[80:81], v3 offset:16384
    ds_read_b64_tr_b16 v[82:83], v3 offset:17408
    ds_read_b128 v[96:99], v7 offset:0
    ds_read_b128 v[100:103], v7 offset:2048
    ds_read_b128 v[104:107], v7 offset:4096
    ds_read_b128 v[108:111], v7 offset:6144
    ds_read_b64_tr_b16 v[84:85], v4 offset:16384
    ds_read_b64_tr_b16 v[86:87], v4 offset:17408
    ds_read_b64_tr_b16 v[88:89], v5 offset:16384
    ds_read_b64_tr_b16 v[90:91], v5 offset:17408
    ds_read_b64_tr_b16 v[92:93], v6 offset:16384
    ds_read_b64_tr_b16 v[94:95], v6 offset:17408
P1_Q:
    s_mov_b32 s38, 0
Q_LOOP:
    s_waitcnt lgkmcnt(4)
    v_mfma_f32_16x16x32_bf16 v[16:19], v[80:83], v[96:99], v[16:19]
    ds_read_b64_tr_b16 v[112:113], v3 offset:24576
    s_and_b32 s29, s38, 3
    v_mfma_f32_16x16x32_bf16 v[24:27], v[80:83], v[100:103], v[24:27]
    ds_read_b64_tr_b16 v[114:115], v3 offset:25600
    s_cmp_eq_u32 s29, 3
    v_mfma_f32_16x16x32_bf16 v[32:35], v[80:83], v[104:107], v[32:35]
    ds_read_b128 v[128:131], v8 offset:0
    s_cselect_b32 s29, 0xfffe8000, s39
    v_mfma_f32_16x16x32_bf16 v[40:43], v[80:83], v[108:111], v[40:43]
    ds_read_b128 v[132:135], v8 offset:2048
    s_add_u32 s38, s38, 1
    v_mfma_f32_16x16x32_bf16 v[20:23], v[84:87], v[96:99], v[20:23]
    ds_read_b128 v[136:139], v8 offset:4096
    s_cmp_eq_u32 s38, 2
    v_mfma_f32_16x16x32_bf16 v[28:31], v[84:87], v[100:103], v[28:31]
    ds_read_b128 v[140:143], v8 offset:6144
    v_mfma_f32_16x16x32_bf16 v[36:39], v[84:87], v[104:107], v[36:39]
    ds_read_b64_tr_b16 v[116:117], v4 offset:24576
    v_mfma_f32_16x16x32_bf16 v[44:47], v[84:87], v[108:111], v[44:47]
    ds_read_b64_tr_b16 v[118:119], v4 offset:25600
    s_waitcnt lgkmcnt(10)
    v_mfma_f32_16x16x32_bf16 v[48:51], v[88:91], v[96:99], v[48:51]
    ds_read_b64_tr_b16 v[120:121], v5 offset:24576
    v_mfma_f32_16x16x32_bf16 v[56:59], v[88:91], v[100:103], v[56:59]
    ds_read_b64_tr_b16 v[122:123], v5 offset:25600
    v_mfma_f32_16x16x32_bf16 v[64:67], v[88:91], v[104:107], v[64:67]
    ds_read_b64_tr_b16 v[124:125], v6 offset:24576
    v_mfma_f32_16x16x32_bf16 v[72:75], v[88:91], v[108:111], v[72:75]
    ds_read_b64_tr_b16 v[126:127], v6 offset:25600
    s_waitcnt lgkmcnt(12)
    v_mfma_f32_16x16x32_bf16 v[52:55], v[92:95], v[96:99], v[52:55]
    v_add_u32 v7, s29, v7
    v_add_u32 v8, s29, v8
    v_mfma_f32_16x16x32_bf16 v[60:63], v[92:95], v[100:103], v[60:63]
    v_add_u32 v3, s29, v3
    v_add_u32 v4, s29, v4
    v_mfma_f32_16x16x32_bf16 v[68:71], v[92:95], v[104:107], v[68:71]
    v_add_u32 v5, s29, v5
    v_add_u32 v6, s29, v6
    v_mfma_f32_16x16x32_bf16 v[76:79], v[92:95], v[108:111], v[76:79]
    s_cbranch_scc1 Q_PRE
Q_PRE_RET:
    s_waitcnt lgkmcnt(0)
    s_barrier
    v_mfma_f32_16x16x32_bf16 v[16:19], v[112:115], v[128:131], v[16:19]
    ds_read_b64_tr_b16 v[80:81], v3 offset:16384
    v_mfma_f32_16x16x32_bf16 v[24:27], v[112:115], v[132:135], v[24:27]
    ds_read_b64_tr_b16 v[82:83], v3 offset:17408
    v_mfma_f32_16x16x32_bf16 v[32:35], v[112:115], v[136:139], v[32:35]
    ds_read_b128 v[96:99], v7 offset:0
    v_mfma_f32_16x16x32_bf16 v[40:43], v[112:115], v[140:143], v[40:43]
    ds_read_b128 v[100:103], v7 offset:2048
    v_mfma_f32_16x16x32_bf16 v[20:23], v[116:119], v[128:131], v[20:23]
    ds_read_b128 v[104:107], v7 offset:4096
    v_mfma_f32_16x16x32_bf16 v[28:31], v[116:119], v[132:135], v[28:31]
    ds_read_b128 v[108:111], v7 offset:6144
    v_mfma_f32_16x16x32_bf16 v[36:39], v[116:119], v[136:139], v[36:39]
    ds_read_b64_tr_b16 v[84:85], v4 offset:16384
    v_mfma_f32_16x16x32_bf16 v[44:47], v[116:119], v[140:143], v[44:47]
    ds_read_b64_tr_b16 v[86:87], v4 offset:17408
    v_mfma_f32_16x16x32_bf16 v[48:51], v[120:123], v[128:131], v[48:51]
    ds_read_b64_tr_b16 v[88:89], v5 offset:16384
    v_mfma_f32_16x16x32_bf16 v[56:59], v[120:123], v[132:135], v[56:59]
    ds_read_b64_tr_b16 v[90:91], v5 offset:17408
    v_mfma_f32_16x16x32_bf16 v[64:67], v[120:123], v[136:139], v[64:67]
    ds_read_b64_tr_b16 v[92:93], v6 offset:16384
    v_mfma_f32_16x16x32_bf16 v[72:75], v[120:123], v[140:143], v[72:75]
    ds_read_b64_tr_b16 v[94:95], v6 offset:17408
    v_mfma_f32_16x16x32_bf16 v[52:55], v[124:127], v[128:131], v[52:55]
    v_mfma_f32_16x16x32_bf16 v[60:63], v[124:127], v[132:135], v[60:63]
    s_bitcmp1_b32 s45, s38
    s_cbranch_scc1 Q_POST
Q_POST_RET:
    v_mfma_f32_16x16x32_bf16 v[68:71], v[124:127], v[136:139], v[68:71]
    v_mfma_f32_16x16x32_bf16 v[76:79], v[124:127], v[140:143], v[76:79]
    s_cmp_lt_u32 s38, 15
    s_cbranch_scc1 Q_LOOP
    s_branch Q_LAST
Q_PRE:
    s_waitcnt vmcnt(0)
    s_branch Q_PRE_RET
Q_POST:
    s_cmp_eq_u32 s38, 11
    s_cbranch_scc1 Q_POLL
    s_cmp_eq_u32 s38, 13
    s_cbranch_scc1 Q_CHECK
    s_and_b32 s30, s2, 1
    s_lshl_b32 s30, s30, 7
    v_mov_b32 v0, s30
    v_mov_b32 v11, 1
    s_mov_b64 exec, 1
    global_atomic_add v0, v11, s[58:59] sc1
    s_mov_b64 exec, -1
    s_branch Q_POST_RET
Q_POLL:
    v_and_b32 v0, 1, v1
    v_lshlrev_b32 v0, 7, v0
    v_mov_b32 v11, 128
    global_load_dword v10, v0, s[58:59] sc1
    s_branch Q_POST_RET
Q_CHECK:
    s_waitcnt vmcnt(0)
    v_cmp_lt_u32 vcc, v10, v11
    s_nop 1
    s_cbranch_vccz Q_POST_RET
    s_mov_b32 s30, 0x40000
POLL_KV:
    global_load_dword v10, v0, s[58:59] sc1
    s_waitcnt vmcnt(0)
    v_cmp_lt_u32 vcc, v10, v11
    s_sub_u32 s30, s30, 1
    s_cbranch_scc1 POLLD_KV
    s_cbranch_vccz POLLD_KV
    s_sleep 8
    s_branch POLL_KV
POLLD_KV:
    s_branch Q_POST_RET
Q_LAST:
    s_waitcnt lgkmcnt(4)
    v_mfma_f32_16x16x32_bf16 v[16:19], v[80:83], v[96:99], v[16:19]
    ds_read_b64_tr_b16 v[112:113], v3 offset:24576
    v_mfma_f32_16x16x32_bf16 v[24:27], v[80:83], v[100:103], v[24:27]
    ds_read_b64_tr_b16 v[114:115], v3 offset:25600
    v_mfma_f32_16x16x32_bf16 v[32:35], v[80:83], v[104:107], v[32:35]
    ds_read_b128 v[128:131], v8 offset:0
    v_mfma_f32_16x16x32_bf16 v[40:43], v[80:83], v[108:111], v[40:43]
    ds_read_b128 v[132:135], v8 offset:2048
    v_mfma_f32_16x16x32_bf16 v[20:23], v[84:87], v[96:99], v[20:23]
    ds_read_b128 v[136:139], v8 offset:4096
    v_mfma_f32_16x16x32_bf16 v[28:31], v[84:87], v[100:103], v[28:31]
    ds_read_b128 v[140:143], v8 offset:6144
    v_mfma_f32_16x16x32_bf16 v[36:39], v[84:87], v[104:107], v[36:39]
    ds_read_b64_tr_b16 v[116:117], v4 offset:24576
    v_mfma_f32_16x16x32_bf16 v[44:47], v[84:87], v[108:111], v[44:47]
    ds_read_b64_tr_b16 v[118:119], v4 offset:25600
    s_waitcnt lgkmcnt(10)
    v_mfma_f32_16x16x32_bf16 v[48:51], v[88:91], v[96:99], v[48:51]
    ds_read_b64_tr_b16 v[120:121], v5 offset:24576
    v_mfma_f32_16x16x32_bf16 v[56:59], v[88:91], v[100:103], v[56:59]
    ds_read_b64_tr_b16 v[122:123], v5 offset:25600
    v_mfma_f32_16x16x32_bf16 v[64:67], v[88:91], v[104:107], v[64:67]
    ds_read_b64_tr_b16 v[124:125], v6 offset:24576
    v_mfma_f32_16x16x32_bf16 v[72:75], v[88:91], v[108:111], v[72:75]
    ds_read_b64_tr_b16 v[126:127], v6 offset:25600
    s_waitcnt lgkmcnt(12)
    v_mfma_f32_16x16x32_bf16 v[52:55], v[92:95], v[96:99], v[52:55]
    v_add_u32 v0, 131072, v2
    v_mfma_f32_16x16x32_bf16 v[60:63], v[92:95], v[100:103], v[60:63]
    v_and_b32 v10, 31, v1
    v_mfma_f32_16x16x32_bf16 v[68:71], v[92:95], v[104:107], v[68:71]
    v_lshlrev_b32 v10, 2, v10
    v_mfma_f32_16x16x32_bf16 v[76:79], v[92:95], v[108:111], v[76:79]
    buffer_load_dword v11, v10, s[16:19], s48 offen offset:128 sc1
    buffer_load_dword v10, v10, s[16:19], s48 offen sc1
    s_waitcnt lgkmcnt(0)
    s_barrier
    ds_read_b128 a[16:19], v0 offset:0
    ds_read_b128 a[20:23], v0 offset:1024
    ds_read_b128 a[48:51], v0 offset:2048
    ds_read_b128 a[52:55], v0 offset:3072
    v_mfma_f32_16x16x32_bf16 v[16:19], v[112:115], v[128:131], v[16:19]
    v_mov_b32 v80, 0
    v_mov_b32 v81, 0
    v_mfma_f32_16x16x32_bf16 v[24:27], v[112:115], v[132:135], v[24:27]
    v_mov_b32 v82, 0
    v_mov_b32 v83, 0
    v_mfma_f32_16x16x32_bf16 v[20:23], v[116:119], v[128:131], v[20:23]
    v_mov_b32 v84, 0
    v_mov_b32 v85, 0
    v_mfma_f32_16x16x32_bf16 v[28:31], v[116:119], v[132:135], v[28:31]
    v_mov_b32 v86, 0
    v_mov_b32 v87, 0
    v_mfma_f32_16x16x32_bf16 v[32:35], v[112:115], v[136:139], v[32:35]
    v_mov_b32 v88, 0
    v_mov_b32 v89, 0
    v_mfma_f32_16x16x32_bf16 v[40:43], v[112:115], v[140:143], v[40:43]
    v_mov_b32 v90, 0
    v_mov_b32 v91, 0
    v_mfma_f32_16x16x32_bf16 v[36:39], v[116:119], v[136:139], v[36:39]
    v_mov_b32 v92, 0
    v_mov_b32 v93, 0
    v_mfma_f32_16x16x32_bf16 v[44:47], v[116:119], v[140:143], v[44:47]
    v_mov_b32 v94, 0
    v_mov_b32 v95, 0
    v_mfma_f32_16x16x32_bf16 v[48:51], v[120:123], v[128:131], v[48:51]
    v_mov_b32 v96, 0
    v_mov_b32 v97, 0
    v_mfma_f32_16x16x32_bf16 v[56:59], v[120:123], v[132:135], v[56:59]
    v_mov_b32 v98, 0
    v_mov_b32 v99, 0
    v_mfma_f32_16x16x32_bf16 v[52:55], v[124:127], v[128:131], v[52:55]
    v_mov_b32 v100, 0
    v_mov_b32 v101, 0
    v_mfma_f32_16x16x32_bf16 v[60:63], v[124:127], v[132:135], v[60:63]
    v_mov_b32 v102, 0
    v_mov_b32 v103, 0
    v_mfma_f32_16x16x32_bf16 v[64:67], v[120:123], v[136:139], v[64:67]
    v_mov_b32 v104, 0
    v_mov_b32 v105, 0
    v_mfma_f32_16x16x32_bf16 v[72:75], v[120:123], v[140:143], v[72:75]
    v_mov_b32 v106, 0
    v_mov_b32 v107, 0
    v_mfma_f32_16x16x32_bf16 v[68:71], v[124:127], v[136:139], v[68:71]
    v_mov_b32 v108, 0
    v_mov_b32 v109, 0
    v_mfma_f32_16x16x32_bf16 v[76:79], v[124:127], v[140:143], v[76:79]
    v_mov_b32 v110, 0
    v_mov_b32 v111, 0
    v_cvt_pk_bf16_f32 v144, v16, v17
    v_cvt_pk_bf16_f32 v145, v18, v19
    v_cvt_pk_bf16_f32 v146, v20, v21
    v_cvt_pk_bf16_f32 v147, v22, v23
    v_cvt_pk_bf16_f32 v148, v24, v25
    v_cvt_pk_bf16_f32 v149, v26, v27
    v_cvt_pk_bf16_f32 v150, v28, v29
    v_cvt_pk_bf16_f32 v151, v30, v31
    v_cvt_pk_bf16_f32 v152, v32, v33
    v_cvt_pk_bf16_f32 v153, v34, v35
    v_cvt_pk_bf16_f32 v154, v36, v37
    v_cvt_pk_bf16_f32 v155, v38, v39
    v_cvt_pk_bf16_f32 v156, v40, v41
    v_cvt_pk_bf16_f32 v157, v42, v43
    v_cvt_pk_bf16_f32 v158, v44, v45
    v_cvt_pk_bf16_f32 v159, v46, v47
    v_permlane16_swap_b32 v144, v148
    v_permlane16_swap_b32 v145, v149
    v_permlane16_swap_b32 v146, v150
    v_permlane16_swap_b32 v147, v151
    s_waitcnt lgkmcnt(0)
    v_cvt_pk_bf16_f32 v160, v48, v49
    v_cvt_pk_bf16_f32 v161, v50, v51
    v_mfma_f32_32x32x16_bf16 v[16:31], a[16:19], v[144:147], 0
    v_cvt_pk_bf16_f32 v162, v52, v53
    v_cvt_pk_bf16_f32 v163, v54, v55
    v_cvt_pk_bf16_f32 v164, v56, v57
    v_cvt_pk_bf16_f32 v165, v58, v59
    v_cvt_pk_bf16_f32 v166, v60, v61
    v_cvt_pk_bf16_f32 v167, v62, v63
    v_permlane16_swap_b32 v152, v156
    v_permlane16_swap_b32 v153, v157
    v_permlane16_swap_b32 v154, v158
    v_permlane16_swap_b32 v155, v159
    v_mfma_f32_32x32x16_bf16 v[16:31], a[20:23], v[148:151], v[16:31]
    v_cvt_pk_bf16_f32 v168, v64, v65
    v_cvt_pk_bf16_f32 v169, v66, v67
    v_cvt_pk_bf16_f32 v170, v68, v69
    v_cvt_pk_bf16_f32 v171, v70, v71
    v_cvt_pk_bf16_f32 v172, v72, v73
    v_cvt_pk_bf16_f32 v173, v74, v75
    v_cvt_pk_bf16_f32 v174, v76, v77
    v_cvt_pk_bf16_f32 v175, v78, v79
    v_permlane16_swap_b32 v160, v164
    v_permlane16_swap_b32 v161, v165
    v_permlane16_swap_b32 v162, v166
    v_permlane16_swap_b32 v163, v167
    v_mov_b32 v112, 0
    v_mov_b32 v113, 0
    v_mov_b32 v114, 0
    v_mov_b32 v115, 0
    v_mov_b32 v116, 0
    v_mov_b32 v117, 0
    v_mov_b32 v118, 0
    v_mov_b32 v119, 0
    v_mov_b32 v120, 0
    v_mov_b32 v121, 0
    v_mov_b32 v122, 0
    v_mov_b32 v123, 0
    v_mov_b32 v124, 0
    v_mov_b32 v125, 0
    v_mov_b32 v126, 0
    v_mov_b32 v127, 0
    v_mov_b32 v128, 0
    v_mov_b32 v129, 0
    v_mov_b32 v130, 0
    v_mov_b32 v131, 0
    v_mov_b32 v132, 0
    v_mov_b32 v133, 0
    v_mov_b32 v134, 0
    v_mov_b32 v135, 0
    v_mov_b32 v136, 0
    v_mov_b32 v137, 0
    v_mov_b32 v138, 0
    v_mov_b32 v139, 0
    v_mov_b32 v140, 0
    v_mov_b32 v141, 0
    v_mov_b32 v142, 0
    v_mov_b32 v143, 0
    v_permlane16_swap_b32 v168, v172
    v_permlane16_swap_b32 v169, v173
    v_permlane16_swap_b32 v170, v174
    v_permlane16_swap_b32 v171, v175
    v_mov_b32 v72, 0
    v_mov_b32 v73, 0
    v_mov_b32 v74, 0
    v_mov_b32 v75, 0
    v_mov_b32 v76, 0
    v_mov_b32 v77, 0
    v_mov_b32 v78, 0
    v_mov_b32 v79, 0
    s_mov_b32 s36, 12
    v_add_u32 v3, 98304, v2
    v_and_b32 v8, 15, v1
    v_bfe_u32 v4, v1, 4, 1
    v_lshl_add_u32 v8, v4, 6, v8
    v_lshrrev_b32 v4, 5, v1
    v_lshl_add_u32 v8, v4, 4, v8
    v_lshlrev_b32 v1, 4, v8
    v_mov_b32 v4, 1.0
    v_mov_b32 v5, 1.0
    v_mov_b32 v6, 0
    v_mov_b32 v7, 0
.p2align 6
AT_LOOP:
    v_mfma_f32_32x32x16_bf16 v[32:47], a[16:19], v[152:155], 0
    s_waitcnt lgkmcnt(0)
    v_exp_f32 v16, v16
    v_exp_f32 v17, v17
    v_exp_f32 v18, v18
    v_mfma_f32_32x32x16_bf16 v[32:47], a[20:23], v[156:159], v[32:47]
    v_exp_f32 v19, v19
    v_exp_f32 v20, v20
    v_exp_f32 v21, v21
    v_smfmac_f32_32x32x32_bf16 v[128:143], a[60:63], v[72:79], v9
    v_exp_f32 v22, v22
    v_exp_f32 v23, v23
    v_exp_f32 v24, v24
    v_smfmac_f32_16x16x64_bf16 a[12:15], v[12:15], v[72:79], v9
    ds_read_b128 a[24:27], v0 offset:4096
    v_exp_f32 v25, v25
    v_exp_f32 v26, v26
    v_smfmac_f32_32x32x32_bf16 v[80:95], a[48:51], v[16:23], v9
    v_exp_f32 v27, v27
    v_exp_f32 v28, v28
    v_exp_f32 v29, v29
    v_smfmac_f32_16x16x64_bf16 a[0:3], v[12:15], v[16:23], v9
    v_exp_f32 v30, v30
    v_exp_f32 v31, v31
    v_mfma_f32_32x32x16_bf16 v[48:63], a[16:19], v[160:163], 0
    v_exp_f32 v32, v32
    v_exp_f32 v33, v33
    v_exp_f32 v34, v34
    v_mfma_f32_32x32x16_bf16 v[48:63], a[20:23], v[164:167], v[48:63]
    v_exp_f32 v35, v35
    v_exp_f32 v36, v36
    v_exp_f32 v37, v37
    v_smfmac_f32_32x32x32_bf16 v[80:95], a[52:55], v[24:31], v9
    v_exp_f32 v38, v38
    v_exp_f32 v39, v39
    v_exp_f32 v40, v40
    v_smfmac_f32_16x16x64_bf16 a[0:3], v[12:15], v[24:31], v9
    ds_read_b128 a[28:31], v0 offset:5120
    v_exp_f32 v41, v41
    v_exp_f32 v42, v42
    v_smfmac_f32_32x32x32_bf16 v[96:111], a[48:51], v[32:39], v9
    v_exp_f32 v43, v43
    v_exp_f32 v44, v44
    v_exp_f32 v45, v45
    v_smfmac_f32_16x16x64_bf16 a[4:7], v[12:15], v[32:39], v9
    v_exp_f32 v46, v46
    v_exp_f32 v47, v47
    v_mfma_f32_32x32x16_bf16 v[64:79], a[16:19], v[168:171], 0
    v_exp_f32 v48, v48
    v_exp_f32 v49, v49
    v_exp_f32 v50, v50
    v_mfma_f32_32x32x16_bf16 v[64:79], a[20:23], v[172:175], v[64:79]
    v_exp_f32 v51, v51
    v_exp_f32 v52, v52
    v_exp_f32 v53, v53
    v_smfmac_f32_32x32x32_bf16 v[96:111], a[52:55], v[40:47], v9
    v_exp_f32 v54, v54
    v_exp_f32 v55, v55
    v_exp_f32 v56, v56
    v_smfmac_f32_16x16x64_bf16 a[4:7], v[12:15], v[40:47], v9
    ds_read_b128 a[56:59], v0 offset:6144
    v_exp_f32 v57, v57
    v_exp_f32 v58, v58
    v_smfmac_f32_32x32x32_bf16 v[112:127], a[48:51], v[48:55], v9
    v_exp_f32 v59, v59
    v_exp_f32 v60, v60
    v_exp_f32 v61, v61
    v_smfmac_f32_16x16x64_bf16 a[8:11], v[12:15], v[48:55], v9
    s_waitcnt lgkmcnt(1)
    v_exp_f32 v62, v62
    v_exp_f32 v63, v63
    v_mfma_f32_32x32x16_bf16 v[16:31], a[24:27], v[144:147], 0
    v_exp_f32 v64, v64
    v_exp_f32 v65, v65
    v_exp_f32 v66, v66
    v_mfma_f32_32x32x16_bf16 v[16:31], a[28:31], v[148:151], v[16:31]
    v_exp_f32 v67, v67
    v_exp_f32 v68, v68
    v_exp_f32 v69, v69
    v_smfmac_f32_32x32x32_bf16 v[112:127], a[52:55], v[56:63], v9
    v_exp_f32 v70, v70
    v_exp_f32 v71, v71
    v_exp_f32 v72, v72
    v_smfmac_f32_16x16x64_bf16 a[8:11], v[12:15], v[56:63], v9
    ds_read_b128 a[60:63], v0 offset:7168
    v_exp_f32 v73, v73
    v_exp_f32 v74, v74
    v_smfmac_f32_32x32x32_bf16 v[128:143], a[48:51], v[64:71], v9
    v_exp_f32 v75, v75
    v_exp_f32 v76, v76
    v_exp_f32 v77, v77
    v_smfmac_f32_16x16x64_bf16 a[12:15], v[12:15], v[64:71], v9
    v_exp_f32 v78, v78
    v_exp_f32 v79, v79
    v_mfma_f32_32x32x16_bf16 v[32:47], a[24:27], v[152:155], 0
    s_waitcnt lgkmcnt(0)
    v_exp_f32 v16, v16
    v_exp_f32 v17, v17
    v_exp_f32 v18, v18
    v_mfma_f32_32x32x16_bf16 v[32:47], a[28:31], v[156:159], v[32:47]
    v_exp_f32 v19, v19
    v_exp_f32 v20, v20
    v_exp_f32 v21, v21
    v_smfmac_f32_32x32x32_bf16 v[128:143], a[52:55], v[72:79], v9
    v_exp_f32 v22, v22
    v_exp_f32 v23, v23
    v_exp_f32 v24, v24
    v_smfmac_f32_16x16x64_bf16 a[12:15], v[12:15], v[72:79], v9
    ds_read_b128 a[16:19], v0 offset:8192
    v_exp_f32 v25, v25
    v_exp_f32 v26, v26
    v_smfmac_f32_32x32x32_bf16 v[80:95], a[56:59], v[16:23], v9
    v_exp_f32 v27, v27
    v_exp_f32 v28, v28
    v_exp_f32 v29, v29
    v_smfmac_f32_16x16x64_bf16 a[0:3], v[12:15], v[16:23], v9
    v_exp_f32 v30, v30
    v_exp_f32 v31, v31
    v_mfma_f32_32x32x16_bf16 v[48:63], a[24:27], v[160:163], 0
    v_exp_f32 v32, v32
    v_exp_f32 v33, v33
    v_exp_f32 v34, v34
    v_mfma_f32_32x32x16_bf16 v[48:63], a[28:31], v[164:167], v[48:63]
    v_exp_f32 v35, v35
    v_exp_f32 v36, v36
    v_exp_f32 v37, v37
    v_smfmac_f32_32x32x32_bf16 v[80:95], a[60:63], v[24:31], v9
    v_exp_f32 v38, v38
    v_exp_f32 v39, v39
    v_exp_f32 v40, v40
    v_smfmac_f32_16x16x64_bf16 a[0:3], v[12:15], v[24:31], v9
    ds_read_b128 a[20:23], v0 offset:9216
    v_exp_f32 v41, v41
    v_exp_f32 v42, v42
    v_smfmac_f32_32x32x32_bf16 v[96:111], a[56:59], v[32:39], v9
    v_exp_f32 v43, v43
    v_exp_f32 v44, v44
    v_exp_f32 v45, v45
    v_smfmac_f32_16x16x64_bf16 a[4:7], v[12:15], v[32:39], v9
    v_exp_f32 v46, v46
    v_exp_f32 v47, v47
    v_mfma_f32_32x32x16_bf16 v[64:79], a[24:27], v[168:171], 0
    v_exp_f32 v48, v48
    v_exp_f32 v49, v49
    v_exp_f32 v50, v50
    v_mfma_f32_32x32x16_bf16 v[64:79], a[28:31], v[172:175], v[64:79]
    v_exp_f32 v51, v51
    v_exp_f32 v52, v52
    v_exp_f32 v53, v53
    v_smfmac_f32_32x32x32_bf16 v[96:111], a[60:63], v[40:47], v9
    v_exp_f32 v54, v54
    v_exp_f32 v55, v55
    v_exp_f32 v56, v56
    v_smfmac_f32_16x16x64_bf16 a[4:7], v[12:15], v[40:47], v9
    ds_read_b128 a[48:51], v0 offset:10240
    v_exp_f32 v57, v57
    v_exp_f32 v58, v58
    v_smfmac_f32_32x32x32_bf16 v[112:127], a[56:59], v[48:55], v9
    v_exp_f32 v59, v59
    v_exp_f32 v60, v60
    v_exp_f32 v61, v61
    v_smfmac_f32_16x16x64_bf16 a[8:11], v[12:15], v[48:55], v9
    s_waitcnt lgkmcnt(1)
    v_exp_f32 v62, v62
    v_exp_f32 v63, v63
    v_mfma_f32_32x32x16_bf16 v[16:31], a[16:19], v[144:147], 0
    v_exp_f32 v64, v64
    v_exp_f32 v65, v65
    v_exp_f32 v66, v66
    v_mfma_f32_32x32x16_bf16 v[16:31], a[20:23], v[148:151], v[16:31]
    v_exp_f32 v67, v67
    v_exp_f32 v68, v68
    v_exp_f32 v69, v69
    v_smfmac_f32_32x32x32_bf16 v[112:127], a[60:63], v[56:63], v9
    v_exp_f32 v70, v70
    v_exp_f32 v71, v71
    v_exp_f32 v72, v72
    v_smfmac_f32_16x16x64_bf16 a[8:11], v[12:15], v[56:63], v9
    ds_read_b128 a[52:55], v0 offset:11264
    v_exp_f32 v73, v73
    v_exp_f32 v74, v74
    v_smfmac_f32_32x32x32_bf16 v[128:143], a[56:59], v[64:71], v9
    v_exp_f32 v75, v75
    v_exp_f32 v76, v76
    v_exp_f32 v77, v77
    v_smfmac_f32_16x16x64_bf16 a[12:15], v[12:15], v[64:71], v9
    v_exp_f32 v78, v78
    v_exp_f32 v79, v79
    v_mfma_f32_32x32x16_bf16 v[32:47], a[16:19], v[152:155], 0
    s_waitcnt lgkmcnt(0)
    v_exp_f32 v16, v16
    v_exp_f32 v17, v17
    v_exp_f32 v18, v18
    v_mfma_f32_32x32x16_bf16 v[32:47], a[20:23], v[156:159], v[32:47]
    v_exp_f32 v19, v19
    v_exp_f32 v20, v20
    v_exp_f32 v21, v21
    v_smfmac_f32_32x32x32_bf16 v[128:143], a[60:63], v[72:79], v9
    v_exp_f32 v22, v22
    v_exp_f32 v23, v23
    v_exp_f32 v24, v24
    v_smfmac_f32_16x16x64_bf16 a[12:15], v[12:15], v[72:79], v9
    ds_read_b128 a[24:27], v0 offset:12288
    v_exp_f32 v25, v25
    v_exp_f32 v26, v26
    v_smfmac_f32_32x32x32_bf16 v[80:95], a[48:51], v[16:23], v9
    v_exp_f32 v27, v27
    v_exp_f32 v28, v28
    v_exp_f32 v29, v29
    v_smfmac_f32_16x16x64_bf16 a[0:3], v[12:15], v[16:23], v9
    v_exp_f32 v30, v30
    v_exp_f32 v31, v31
    v_mfma_f32_32x32x16_bf16 v[48:63], a[16:19], v[160:163], 0
    v_exp_f32 v32, v32
    v_exp_f32 v33, v33
    v_exp_f32 v34, v34
    v_mfma_f32_32x32x16_bf16 v[48:63], a[20:23], v[164:167], v[48:63]
    s_add_u32 s33, s33, 16384
    v_exp_f32 v35, v35
    v_exp_f32 v36, v36
    v_exp_f32 v37, v37
    v_smfmac_f32_32x32x32_bf16 v[80:95], a[52:55], v[24:31], v9
    v_exp_f32 v38, v38
    v_exp_f32 v39, v39
    v_exp_f32 v40, v40
    v_smfmac_f32_16x16x64_bf16 a[0:3], v[12:15], v[24:31], v9
    ds_read_b128 a[28:31], v0 offset:13312
    v_exp_f32 v41, v41
    v_exp_f32 v42, v42
    v_smfmac_f32_32x32x32_bf16 v[96:111], a[48:51], v[32:39], v9
    v_exp_f32 v43, v43
    v_exp_f32 v44, v44
    v_exp_f32 v45, v45
    v_smfmac_f32_16x16x64_bf16 a[4:7], v[12:15], v[32:39], v9
    v_exp_f32 v46, v46
    v_exp_f32 v47, v47
    v_mfma_f32_32x32x16_bf16 v[64:79], a[16:19], v[168:171], 0
    v_exp_f32 v48, v48
    v_exp_f32 v49, v49
    v_exp_f32 v50, v50
    v_mfma_f32_32x32x16_bf16 v[64:79], a[20:23], v[172:175], v[64:79]
    s_and_b32 s33, s33, 0xffff
    v_exp_f32 v51, v51
    v_exp_f32 v52, v52
    v_exp_f32 v53, v53
    v_smfmac_f32_32x32x32_bf16 v[96:111], a[52:55], v[40:47], v9
    v_exp_f32 v54, v54
    v_exp_f32 v55, v55
    v_exp_f32 v56, v56
    v_smfmac_f32_16x16x64_bf16 a[4:7], v[12:15], v[40:47], v9
    ds_read_b128 a[56:59], v0 offset:14336
    v_exp_f32 v57, v57
    v_exp_f32 v58, v58
    v_smfmac_f32_32x32x32_bf16 v[112:127], a[48:51], v[48:55], v9
    v_exp_f32 v59, v59
    v_exp_f32 v60, v60
    v_exp_f32 v61, v61
    v_smfmac_f32_16x16x64_bf16 a[8:11], v[12:15], v[48:55], v9
    s_waitcnt lgkmcnt(1)
    v_exp_f32 v62, v62
    v_exp_f32 v63, v63
    v_mfma_f32_32x32x16_bf16 v[16:31], a[24:27], v[144:147], 0
    v_exp_f32 v64, v64
    v_exp_f32 v65, v65
    v_exp_f32 v66, v66
    v_mfma_f32_32x32x16_bf16 v[16:31], a[28:31], v[148:151], v[16:31]
    v_exp_f32 v67, v67
    v_exp_f32 v68, v68
    v_exp_f32 v69, v69
    v_smfmac_f32_32x32x32_bf16 v[112:127], a[52:55], v[56:63], v9
    v_exp_f32 v70, v70
    v_exp_f32 v71, v71
    v_exp_f32 v72, v72
    v_smfmac_f32_16x16x64_bf16 a[8:11], v[12:15], v[56:63], v9
    ds_read_b128 a[60:63], v0 offset:15360
    v_exp_f32 v73, v73
    v_exp_f32 v74, v74
    v_smfmac_f32_32x32x32_bf16 v[128:143], a[48:51], v[64:71], v9
    v_exp_f32 v75, v75
    v_exp_f32 v76, v76
    v_exp_f32 v77, v77
    v_smfmac_f32_16x16x64_bf16 a[12:15], v[12:15], v[64:71], v9
    v_exp_f32 v78, v78
    v_exp_f32 v79, v79
    v_mfma_f32_32x32x16_bf16 v[32:47], a[24:27], v[152:155], 0
    s_waitcnt lgkmcnt(0)
    s_barrier
    v_exp_f32 v16, v16
    v_exp_f32 v17, v17
    v_exp_f32 v18, v18
    v_mfma_f32_32x32x16_bf16 v[32:47], a[28:31], v[156:159], v[32:47]
    v_exp_f32 v19, v19
    v_exp_f32 v20, v20
    v_exp_f32 v21, v21
    v_smfmac_f32_32x32x32_bf16 v[128:143], a[52:55], v[72:79], v9
    v_add_u32 v0, s33, v3
    v_exp_f32 v22, v22
    v_exp_f32 v23, v23
    v_exp_f32 v24, v24
    v_smfmac_f32_16x16x64_bf16 a[12:15], v[12:15], v[72:79], v9
    ds_read_b128 a[16:19], v0 offset:0
    v_exp_f32 v25, v25
    v_exp_f32 v26, v26
    v_smfmac_f32_32x32x32_bf16 v[80:95], a[56:59], v[16:23], v9
    v_exp_f32 v27, v27
    v_exp_f32 v28, v28
    v_exp_f32 v29, v29
    v_smfmac_f32_16x16x64_bf16 a[0:3], v[12:15], v[16:23], v9
    v_exp_f32 v30, v30
    v_exp_f32 v31, v31
    v_mfma_f32_32x32x16_bf16 v[48:63], a[24:27], v[160:163], 0
    v_exp_f32 v32, v32
    v_exp_f32 v33, v33
    v_exp_f32 v34, v34
    v_mfma_f32_32x32x16_bf16 v[48:63], a[28:31], v[164:167], v[48:63]
    v_exp_f32 v35, v35
    v_exp_f32 v36, v36
    v_exp_f32 v37, v37
    v_smfmac_f32_32x32x32_bf16 v[80:95], a[60:63], v[24:31], v9
    v_exp_f32 v38, v38
    v_exp_f32 v39, v39
    v_exp_f32 v40, v40
    v_smfmac_f32_16x16x64_bf16 a[0:3], v[12:15], v[24:31], v9
    ds_read_b128 a[20:23], v0 offset:1024
    v_exp_f32 v41, v41
    v_exp_f32 v42, v42
    v_smfmac_f32_32x32x32_bf16 v[96:111], a[56:59], v[32:39], v9
    v_exp_f32 v43, v43
    v_exp_f32 v44, v44
    v_exp_f32 v45, v45
    v_smfmac_f32_16x16x64_bf16 a[4:7], v[12:15], v[32:39], v9
    v_exp_f32 v46, v46
    v_exp_f32 v47, v47
    v_mfma_f32_32x32x16_bf16 v[64:79], a[24:27], v[168:171], 0
    v_exp_f32 v48, v48
    v_exp_f32 v49, v49
    v_exp_f32 v50, v50
    v_mfma_f32_32x32x16_bf16 v[64:79], a[28:31], v[172:175], v[64:79]
    s_sub_u32 s36, s36, 1
    v_exp_f32 v51, v51
    v_exp_f32 v52, v52
    v_exp_f32 v53, v53
    v_smfmac_f32_32x32x32_bf16 v[96:111], a[60:63], v[40:47], v9
    v_exp_f32 v54, v54
    v_exp_f32 v55, v55
    v_exp_f32 v56, v56
    v_smfmac_f32_16x16x64_bf16 a[4:7], v[12:15], v[40:47], v9
    ds_read_b128 a[48:51], v0 offset:2048
    v_exp_f32 v57, v57
    v_exp_f32 v58, v58
    v_smfmac_f32_32x32x32_bf16 v[112:127], a[56:59], v[48:55], v9
    v_exp_f32 v59, v59
    v_exp_f32 v60, v60
    v_exp_f32 v61, v61
    v_smfmac_f32_16x16x64_bf16 a[8:11], v[12:15], v[48:55], v9
    s_waitcnt lgkmcnt(1)
    v_exp_f32 v62, v62
    v_exp_f32 v63, v63
    v_mfma_f32_32x32x16_bf16 v[16:31], a[16:19], v[144:147], 0
    v_exp_f32 v64, v64
    v_exp_f32 v65, v65
    v_exp_f32 v66, v66
    v_mfma_f32_32x32x16_bf16 v[16:31], a[20:23], v[148:151], v[16:31]
    v_exp_f32 v67, v67
    v_exp_f32 v68, v68
    v_exp_f32 v69, v69
    v_smfmac_f32_32x32x32_bf16 v[112:127], a[60:63], v[56:63], v9
    v_exp_f32 v70, v70
    v_exp_f32 v71, v71
    v_exp_f32 v72, v72
    v_smfmac_f32_16x16x64_bf16 a[8:11], v[12:15], v[56:63], v9
    ds_read_b128 a[52:55], v0 offset:3072
    v_exp_f32 v73, v73
    v_exp_f32 v74, v74
    v_smfmac_f32_32x32x32_bf16 v[128:143], a[56:59], v[64:71], v9
    v_exp_f32 v75, v75
    v_exp_f32 v76, v76
    v_exp_f32 v77, v77
    v_smfmac_f32_16x16x64_bf16 a[12:15], v[12:15], v[64:71], v9
    s_cmp_lg_u32 s36, 0
    v_exp_f32 v78, v78
    v_exp_f32 v79, v79
    s_cbranch_scc1 AT_LOOP
    v_mfma_f32_32x32x16_bf16 v[32:47], a[16:19], v[152:155], 0
    s_waitcnt lgkmcnt(0)
    ds_read_b128 a[24:27], v3 offset:36864
    v_exp_f32 v16, v16
    v_exp_f32 v17, v17
    v_exp_f32 v18, v18
    v_mfma_f32_32x32x16_bf16 v[32:47], a[20:23], v[156:159], v[32:47]
    ds_read_b128 a[28:31], v3 offset:37888
    v_exp_f32 v19, v19
    v_exp_f32 v20, v20
    v_exp_f32 v21, v21
    v_smfmac_f32_32x32x32_bf16 v[128:143], a[60:63], v[72:79], v9
    v_exp_f32 v22, v22
    v_exp_f32 v23, v23
    v_exp_f32 v24, v24
    v_smfmac_f32_16x16x64_bf16 a[12:15], v[12:15], v[72:79], v9
    ds_read_b128 a[56:59], v3 offset:38912
    ds_read_b128 a[60:63], v3 offset:39936
    v_exp_f32 v25, v25
    v_exp_f32 v26, v26
    v_smfmac_f32_32x32x32_bf16 v[80:95], a[48:51], v[16:23], v9
    v_exp_f32 v27, v27
    v_exp_f32 v28, v28
    v_exp_f32 v29, v29
    v_smfmac_f32_16x16x64_bf16 a[0:3], v[12:15], v[16:23], v9
    ds_read_b128 a[32:35], v3 offset:40960
    ds_read_b128 a[36:39], v3 offset:41984
    s_waitcnt lgkmcnt(4)
    v_exp_f32 v30, v30
    v_exp_f32 v31, v31
    v_mfma_f32_32x32x16_bf16 v[48:63], a[24:27], v[144:147], 0
    v_exp_f32 v32, v32
    v_exp_f32 v33, v33
    v_exp_f32 v34, v34
    v_mfma_f32_32x32x16_bf16 v[48:63], a[28:31], v[148:151], v[48:63]
    v_exp_f32 v35, v35
    v_exp_f32 v36, v36
    v_exp_f32 v37, v37
    v_smfmac_f32_32x32x32_bf16 v[80:95], a[52:55], v[24:31], v9
    v_exp_f32 v38, v38
    v_exp_f32 v39, v39
    v_exp_f32 v40, v40
    v_smfmac_f32_16x16x64_bf16 a[0:3], v[12:15], v[24:31], v9
    ds_read_b128 a[64:67], v3 offset:43008
    v_exp_f32 v41, v41
    v_exp_f32 v42, v42
    v_smfmac_f32_32x32x32_bf16 v[96:111], a[48:51], v[32:39], v9
    v_exp_f32 v43, v43
    v_exp_f32 v44, v44
    v_exp_f32 v45, v45
    v_smfmac_f32_16x16x64_bf16 a[4:7], v[12:15], v[32:39], v9
    ds_read_b128 a[68:71], v3 offset:44032
    v_exp_f32 v46, v46
    v_exp_f32 v47, v47
    v_mfma_f32_32x32x16_bf16 v[64:79], a[24:27], v[152:155], 0
    s_waitcnt lgkmcnt(2)
    v_exp_f32 v48, v48
    v_exp_f32 v49, v49
    v_exp_f32 v50, v50
    v_mfma_f32_32x32x16_bf16 v[64:79], a[28:31], v[156:159], v[64:79]
    s_waitcnt vmcnt(0)
    v_exp_f32 v51, v51
    v_exp_f32 v52, v52
    v_exp_f32 v53, v53
    v_smfmac_f32_32x32x32_bf16 v[96:111], a[52:55], v[40:47], v9
    v_exp_f32 v54, v54
    v_exp_f32 v55, v55
    v_exp_f32 v56, v56
    v_smfmac_f32_16x16x64_bf16 a[4:7], v[12:15], v[40:47], v9
    ds_read_b128 a[40:43], v3 offset:45056
    v_exp_f32 v57, v57
    v_exp_f32 v58, v58
    v_smfmac_f32_32x32x32_bf16 v[80:95], a[56:59], v[48:55], v9
    v_exp_f32 v59, v59
    v_exp_f32 v60, v60
    v_exp_f32 v61, v61
    v_smfmac_f32_16x16x64_bf16 a[0:3], v[12:15], v[48:55], v9
    ds_read_b128 a[44:47], v3 offset:46080
    v_exp_f32 v62, v62
    v_exp_f32 v63, v63
    v_mfma_f32_32x32x16_bf16 v[16:31], a[32:35], v[144:147], 0
    v_exp_f32 v64, v64
    v_exp_f32 v65, v65
    v_exp_f32 v66, v66
    v_mfma_f32_32x32x16_bf16 v[16:31], a[36:39], v[148:151], v[16:31]
    v_exp_f32 v67, v67
    v_exp_f32 v68, v68
    v_exp_f32 v69, v69
    v_smfmac_f32_32x32x32_bf16 v[80:95], a[60:63], v[56:63], v9
    v_exp_f32 v70, v70
    v_exp_f32 v71, v71
    v_exp_f32 v72, v72
    v_smfmac_f32_16x16x64_bf16 a[0:3], v[12:15], v[56:63], v9
    ds_read_b128 a[72:75], v3 offset:47104
    v_exp_f32 v73, v73
    v_exp_f32 v74, v74
    v_smfmac_f32_32x32x32_bf16 v[96:111], a[56:59], v[64:71], v9
    v_exp_f32 v75, v75
    v_exp_f32 v76, v76
    v_exp_f32 v77, v77
    v_smfmac_f32_16x16x64_bf16 a[4:7], v[12:15], v[64:71], v9
    ds_read_b128 a[76:79], v3 offset:48128
    v_exp_f32 v78, v78
    v_exp_f32 v79, v79
    v_mfma_f32_32x32x16_bf16 v[32:47], a[32:35], v[152:155], 0
    s_waitcnt lgkmcnt(2)
    v_exp_f32 v16, v16
    v_exp_f32 v17, v17
    v_exp_f32 v18, v18
    v_mfma_f32_32x32x16_bf16 v[32:47], a[36:39], v[156:159], v[32:47]
    v_exp_f32 v19, v19
    v_exp_f32 v20, v20
    v_exp_f32 v21, v21
    v_smfmac_f32_32x32x32_bf16 v[96:111], a[60:63], v[72:79], v9
    v_exp_f32 v22, v22
    v_exp_f32 v23, v23
    v_exp_f32 v24, v24
    v_smfmac_f32_16x16x64_bf16 a[4:7], v[12:15], v[72:79], v9
    ds_read_b128 a[16:19], v3 offset:49152
    v_exp_f32 v25, v25
    v_exp_f32 v26, v26
    v_smfmac_f32_32x32x32_bf16 v[80:95], a[64:67], v[16:23], v9
    v_exp_f32 v27, v27
    v_exp_f32 v28, v28
    v_exp_f32 v29, v29
    v_smfmac_f32_16x16x64_bf16 a[0:3], v[12:15], v[16:23], v9
    ds_read_b128 a[20:23], v3 offset:50176
    v_exp_f32 v30, v30
    v_exp_f32 v31, v31
    v_mfma_f32_32x32x16_bf16 v[48:63], a[40:43], v[144:147], 0
    v_exp_f32 v32, v32
    v_exp_f32 v33, v33
    v_exp_f32 v34, v34
    v_mfma_f32_32x32x16_bf16 v[48:63], a[44:47], v[148:151], v[48:63]
    v_exp_f32 v35, v35
    v_exp_f32 v36, v36
    v_exp_f32 v37, v37
    v_smfmac_f32_32x32x32_bf16 v[80:95], a[68:71], v[24:31], v9
    v_exp_f32 v38, v38
    v_exp_f32 v39, v39
    v_exp_f32 v40, v40
    v_smfmac_f32_16x16x64_bf16 a[0:3], v[12:15], v[24:31], v9
    ds_read_b128 a[48:51], v3 offset:51200
    v_exp_f32 v41, v41
    v_exp_f32 v42, v42
    v_smfmac_f32_32x32x32_bf16 v[96:111], a[64:67], v[32:39], v9
    v_exp_f32 v43, v43
    v_exp_f32 v44, v44
    v_exp_f32 v45, v45
    v_smfmac_f32_16x16x64_bf16 a[4:7], v[12:15], v[32:39], v9
    ds_read_b128 a[52:55], v3 offset:52224
    v_exp_f32 v46, v46
    v_exp_f32 v47, v47
    v_mfma_f32_32x32x16_bf16 v[64:79], a[40:43], v[152:155], 0
    s_waitcnt lgkmcnt(2)
    v_exp_f32 v48, v48
    v_exp_f32 v49, v49
    v_exp_f32 v50, v50
    v_mfma_f32_32x32x16_bf16 v[64:79], a[44:47], v[156:159], v[64:79]
    v_exp_f32 v51, v51
    v_exp_f32 v52, v52
    v_exp_f32 v53, v53
    v_smfmac_f32_32x32x32_bf16 v[96:111], a[68:71], v[40:47], v9
    v_exp_f32 v54, v54
    v_exp_f32 v55, v55
    v_exp_f32 v56, v56
    v_smfmac_f32_16x16x64_bf16 a[4:7], v[12:15], v[40:47], v9
    ds_read_b128 a[24:27], v3 offset:53248
    v_exp_f32 v57, v57
    v_exp_f32 v58, v58
    v_smfmac_f32_32x32x32_bf16 v[80:95], a[72:75], v[48:55], v9
    v_exp_f32 v59, v59
    v_exp_f32 v60, v60
    v_exp_f32 v61, v61
    v_smfmac_f32_16x16x64_bf16 a[0:3], v[12:15], v[48:55], v9
    ds_read_b128 a[28:31], v3 offset:54272
    v_exp_f32 v62, v62
    v_exp_f32 v63, v63
    v_mfma_f32_32x32x16_bf16 v[16:31], a[16:19], v[144:147], 0
    v_exp_f32 v64, v64
    v_exp_f32 v65, v65
    v_exp_f32 v66, v66
    v_mfma_f32_32x32x16_bf16 v[16:31], a[20:23], v[148:151], v[16:31]
    v_exp_f32 v67, v67
    v_exp_f32 v68, v68
    v_exp_f32 v69, v69
    v_smfmac_f32_32x32x32_bf16 v[80:95], a[76:79], v[56:63], v9
    v_exp_f32 v70, v70
    v_exp_f32 v71, v71
    v_exp_f32 v72, v72
    v_smfmac_f32_16x16x64_bf16 a[0:3], v[12:15], v[56:63], v9
    ds_read_b128 a[56:59], v3 offset:55296
    v_exp_f32 v73, v73
    v_exp_f32 v74, v74
    v_smfmac_f32_32x32x32_bf16 v[96:111], a[72:75], v[64:71], v9
    v_exp_f32 v75, v75
    v_exp_f32 v76, v76
    v_exp_f32 v77, v77
    v_smfmac_f32_16x16x64_bf16 a[4:7], v[12:15], v[64:71], v9
    ds_read_b128 a[60:63], v3 offset:56320
    v_exp_f32 v78, v78
    v_exp_f32 v79, v79
    v_mfma_f32_32x32x16_bf16 v[32:47], a[16:19], v[152:155], 0
    s_waitcnt lgkmcnt(2)
    v_exp_f32 v16, v16
    v_exp_f32 v17, v17
    v_exp_f32 v18, v18
    v_mfma_f32_32x32x16_bf16 v[32:47], a[20:23], v[156:159], v[32:47]
    v_exp_f32 v19, v19
    v_exp_f32 v20, v20
    v_exp_f32 v21, v21
    v_smfmac_f32_32x32x32_bf16 v[96:111], a[76:79], v[72:79], v9
    v_exp_f32 v22, v22
    v_exp_f32 v23, v23
    v_exp_f32 v24, v24
    v_smfmac_f32_16x16x64_bf16 a[4:7], v[12:15], v[72:79], v9
    ds_read_b128 a[32:35], v3 offset:57344
    v_exp_f32 v25, v25
    v_exp_f32 v26, v26
    v_smfmac_f32_32x32x32_bf16 v[80:95], a[48:51], v[16:23], v9
    v_exp_f32 v27, v27
    v_exp_f32 v28, v28
    v_exp_f32 v29, v29
    v_smfmac_f32_16x16x64_bf16 a[0:3], v[12:15], v[16:23], v9
    ds_read_b128 a[36:39], v3 offset:58368
    v_exp_f32 v30, v30
    v_exp_f32 v31, v31
    v_mfma_f32_32x32x16_bf16 v[48:63], a[24:27], v[144:147], 0
    v_exp_f32 v32, v32
    v_exp_f32 v33, v33
    v_exp_f32 v34, v34
    v_mfma_f32_32x32x16_bf16 v[48:63], a[28:31], v[148:151], v[48:63]
    v_exp_f32 v35, v35
    v_exp_f32 v36, v36
    v_exp_f32 v37, v37
    v_smfmac_f32_32x32x32_bf16 v[80:95], a[52:55], v[24:31], v9
    v_exp_f32 v38, v38
    v_exp_f32 v39, v39
    v_exp_f32 v40, v40
    v_smfmac_f32_16x16x64_bf16 a[0:3], v[12:15], v[24:31], v9
    ds_read_b128 a[64:67], v3 offset:59392
    v_exp_f32 v41, v41
    v_exp_f32 v42, v42
    v_smfmac_f32_32x32x32_bf16 v[96:111], a[48:51], v[32:39], v9
    v_exp_f32 v43, v43
    v_exp_f32 v44, v44
    v_exp_f32 v45, v45
    v_smfmac_f32_16x16x64_bf16 a[4:7], v[12:15], v[32:39], v9
    ds_read_b128 a[68:71], v3 offset:60416
    v_exp_f32 v46, v46
    v_exp_f32 v47, v47
    v_mfma_f32_32x32x16_bf16 v[64:79], a[24:27], v[152:155], 0
    s_waitcnt lgkmcnt(2)
    v_exp_f32 v48, v48
    v_exp_f32 v49, v49
    v_exp_f32 v50, v50
    v_mfma_f32_32x32x16_bf16 v[64:79], a[28:31], v[156:159], v[64:79]
    v_exp_f32 v51, v51
    v_exp_f32 v52, v52
    v_exp_f32 v53, v53
    v_smfmac_f32_32x32x32_bf16 v[96:111], a[52:55], v[40:47], v9
    v_exp_f32 v54, v54
    v_exp_f32 v55, v55
    v_exp_f32 v56, v56
    v_smfmac_f32_16x16x64_bf16 a[4:7], v[12:15], v[40:47], v9
    ds_read_b128 a[40:43], v3 offset:61440
    v_exp_f32 v57, v57
    v_exp_f32 v58, v58
    v_smfmac_f32_32x32x32_bf16 v[80:95], a[56:59], v[48:55], v9
    v_exp_f32 v59, v59
    v_exp_f32 v60, v60
    v_exp_f32 v61, v61
    v_smfmac_f32_16x16x64_bf16 a[0:3], v[12:15], v[48:55], v9
    ds_read_b128 a[44:47], v3 offset:62464
    v_exp_f32 v62, v62
    v_exp_f32 v63, v63
    v_mfma_f32_32x32x16_bf16 v[16:31], a[32:35], v[144:147], 0
    v_exp_f32 v64, v64
    v_exp_f32 v65, v65
    v_exp_f32 v66, v66
    v_mfma_f32_32x32x16_bf16 v[16:31], a[36:39], v[148:151], v[16:31]
    v_exp_f32 v67, v67
    v_exp_f32 v68, v68
    v_exp_f32 v69, v69
    v_smfmac_f32_32x32x32_bf16 v[80:95], a[60:63], v[56:63], v9
    v_exp_f32 v70, v70
    v_exp_f32 v71, v71
    v_exp_f32 v72, v72
    v_smfmac_f32_16x16x64_bf16 a[0:3], v[12:15], v[56:63], v9
    ds_read_b128 a[72:75], v3 offset:63488
    v_exp_f32 v73, v73
    v_exp_f32 v74, v74
    v_smfmac_f32_32x32x32_bf16 v[96:111], a[56:59], v[64:71], v9
    v_exp_f32 v75, v75
    v_exp_f32 v76, v76
    v_exp_f32 v77, v77
    v_smfmac_f32_16x16x64_bf16 a[4:7], v[12:15], v[64:71], v9
    ds_read_b128 a[76:79], v3 offset:64512
    v_exp_f32 v78, v78
    v_exp_f32 v79, v79
    v_mfma_f32_32x32x16_bf16 v[32:47], a[32:35], v[152:155], 0
    s_waitcnt lgkmcnt(2)
    v_exp_f32 v16, v16
    v_exp_f32 v17, v17
    v_exp_f32 v18, v18
    v_mfma_f32_32x32x16_bf16 v[32:47], a[36:39], v[156:159], v[32:47]
    v_exp_f32 v19, v19
    v_exp_f32 v20, v20
    v_exp_f32 v21, v21
    v_smfmac_f32_32x32x32_bf16 v[96:111], a[60:63], v[72:79], v9
    v_exp_f32 v22, v22
    v_exp_f32 v23, v23
    v_exp_f32 v24, v24
    v_smfmac_f32_16x16x64_bf16 a[4:7], v[12:15], v[72:79], v9
    ds_read_b128 a[16:19], v3 offset:0
    v_exp_f32 v25, v25
    v_exp_f32 v26, v26
    v_smfmac_f32_32x32x32_bf16 v[80:95], a[64:67], v[16:23], v9
    v_exp_f32 v27, v27
    v_exp_f32 v28, v28
    v_exp_f32 v29, v29
    v_smfmac_f32_16x16x64_bf16 a[0:3], v[12:15], v[16:23], v9
    ds_read_b128 a[20:23], v3 offset:1024
    v_exp_f32 v30, v30
    v_exp_f32 v31, v31
    v_mfma_f32_32x32x16_bf16 v[48:63], a[40:43], v[144:147], 0
    v_exp_f32 v32, v32
    v_exp_f32 v33, v33
    v_exp_f32 v34, v34
    v_mfma_f32_32x32x16_bf16 v[48:63], a[44:47], v[148:151], v[48:63]
    v_exp_f32 v35, v35
    v_exp_f32 v36, v36
    v_exp_f32 v37, v37
    v_smfmac_f32_32x32x32_bf16 v[80:95], a[68:71], v[24:31], v9
    v_exp_f32 v38, v38
    v_exp_f32 v39, v39
    v_exp_f32 v40, v40
    v_smfmac_f32_16x16x64_bf16 a[0:3], v[12:15], v[24:31], v9
    ds_read_b128 a[48:51], v3 offset:2048
    v_exp_f32 v41, v41
    v_exp_f32 v42, v42
    v_smfmac_f32_32x32x32_bf16 v[96:111], a[64:67], v[32:39], v9
    v_exp_f32 v43, v43
    v_exp_f32 v44, v44
    v_exp_f32 v45, v45
    v_smfmac_f32_16x16x64_bf16 a[4:7], v[12:15], v[32:39], v9
    ds_read_b128 a[52:55], v3 offset:3072
    v_exp_f32 v46, v46
    v_exp_f32 v47, v47
    v_mfma_f32_32x32x16_bf16 v[64:79], a[40:43], v[152:155], 0
    s_waitcnt lgkmcnt(2)
    v_exp_f32 v48, v48
    v_exp_f32 v49, v49
    v_exp_f32 v50, v50
    v_mfma_f32_32x32x16_bf16 v[64:79], a[44:47], v[156:159], v[64:79]
    v_exp_f32 v51, v51
    v_exp_f32 v52, v52
    v_exp_f32 v53, v53
    v_smfmac_f32_32x32x32_bf16 v[96:111], a[68:71], v[40:47], v9
    v_exp_f32 v54, v54
    v_exp_f32 v55, v55
    v_exp_f32 v56, v56
    v_smfmac_f32_16x16x64_bf16 a[4:7], v[12:15], v[40:47], v9
    ds_read_b128 a[24:27], v3 offset:4096
    v_exp_f32 v57, v57
    v_exp_f32 v58, v58
    v_smfmac_f32_32x32x32_bf16 v[80:95], a[72:75], v[48:55], v9
    v_exp_f32 v59, v59
    v_exp_f32 v60, v60
    v_exp_f32 v61, v61
    v_smfmac_f32_16x16x64_bf16 a[0:3], v[12:15], v[48:55], v9
    ds_read_b128 a[28:31], v3 offset:5120
    v_exp_f32 v62, v62
    v_exp_f32 v63, v63
    v_mfma_f32_32x32x16_bf16 v[16:31], a[16:19], v[144:147], 0
    v_exp_f32 v64, v64
    v_exp_f32 v65, v65
    v_exp_f32 v66, v66
    v_mfma_f32_32x32x16_bf16 v[16:31], a[20:23], v[148:151], v[16:31]
    v_exp_f32 v67, v67
    v_exp_f32 v68, v68
    v_exp_f32 v69, v69
    v_smfmac_f32_32x32x32_bf16 v[80:95], a[76:79], v[56:63], v9
    v_exp_f32 v70, v70
    v_exp_f32 v71, v71
    v_exp_f32 v72, v72
    v_smfmac_f32_16x16x64_bf16 a[0:3], v[12:15], v[56:63], v9
    ds_read_b128 a[56:59], v3 offset:6144
    v_exp_f32 v73, v73
    v_exp_f32 v74, v74
    v_smfmac_f32_32x32x32_bf16 v[96:111], a[72:75], v[64:71], v9
    v_exp_f32 v75, v75
    v_exp_f32 v76, v76
    v_exp_f32 v77, v77
    v_smfmac_f32_16x16x64_bf16 a[4:7], v[12:15], v[64:71], v9
    ds_read_b128 a[60:63], v3 offset:7168
    v_exp_f32 v78, v78
    v_exp_f32 v79, v79
    v_mfma_f32_32x32x16_bf16 v[32:47], a[16:19], v[152:155], 0
    s_waitcnt lgkmcnt(2)
    v_exp_f32 v16, v16
    v_exp_f32 v17, v17
    v_exp_f32 v18, v18
    v_mfma_f32_32x32x16_bf16 v[32:47], a[20:23], v[156:159], v[32:47]
    v_exp_f32 v19, v19
    v_exp_f32 v20, v20
    v_exp_f32 v21, v21
    v_smfmac_f32_32x32x32_bf16 v[96:111], a[76:79], v[72:79], v9
    v_exp_f32 v22, v22
    v_exp_f32 v23, v23
    v_exp_f32 v24, v24
    v_smfmac_f32_16x16x64_bf16 a[4:7], v[12:15], v[72:79], v9
    ds_read_b128 a[32:35], v3 offset:8192
    v_exp_f32 v25, v25
    v_exp_f32 v26, v26
    v_smfmac_f32_32x32x32_bf16 v[80:95], a[48:51], v[16:23], v9
    v_exp_f32 v27, v27
    v_exp_f32 v28, v28
    v_exp_f32 v29, v29
    v_smfmac_f32_16x16x64_bf16 a[0:3], v[12:15], v[16:23], v9
    ds_read_b128 a[36:39], v3 offset:9216
    v_exp_f32 v30, v30
    v_exp_f32 v31, v31
    v_mfma_f32_32x32x16_bf16 v[48:63], a[24:27], v[144:147], 0
    v_exp_f32 v32, v32
    v_exp_f32 v33, v33
    v_exp_f32 v34, v34
    v_mfma_f32_32x32x16_bf16 v[48:63], a[28:31], v[148:151], v[48:63]
    s_barrier
    v_exp_f32 v35, v35
    v_exp_f32 v36, v36
    v_exp_f32 v37, v37
    v_smfmac_f32_32x32x32_bf16 v[80:95], a[52:55], v[24:31], v9
    v_exp_f32 v38, v38
    v_exp_f32 v39, v39
    v_exp_f32 v40, v40
    v_smfmac_f32_16x16x64_bf16 a[0:3], v[12:15], v[24:31], v9
    ds_read_b128 a[64:67], v3 offset:10240
    v_exp_f32 v41, v41
    v_exp_f32 v42, v42
    v_smfmac_f32_32x32x32_bf16 v[96:111], a[48:51], v[32:39], v9
    v_exp_f32 v43, v43
    v_exp_f32 v44, v44
    v_exp_f32 v45, v45
    v_smfmac_f32_16x16x64_bf16 a[4:7], v[12:15], v[32:39], v9
    ds_read_b128 a[68:71], v3 offset:11264
    v_exp_f32 v46, v46
    v_exp_f32 v47, v47
    v_mfma_f32_32x32x16_bf16 v[64:79], a[24:27], v[152:155], 0
    s_waitcnt lgkmcnt(2)
    v_exp_f32 v48, v48
    v_exp_f32 v49, v49
    v_exp_f32 v50, v50
    v_mfma_f32_32x32x16_bf16 v[64:79], a[28:31], v[156:159], v[64:79]
    v_exp_f32 v51, v51
    v_exp_f32 v52, v52
    v_exp_f32 v53, v53
    v_smfmac_f32_32x32x32_bf16 v[96:111], a[52:55], v[40:47], v9
    v_exp_f32 v54, v54
    v_exp_f32 v55, v55
    v_exp_f32 v56, v56
    v_smfmac_f32_16x16x64_bf16 a[4:7], v[12:15], v[40:47], v9
    ds_read_b128 a[40:43], v3 offset:12288
    v_exp_f32 v57, v57
    v_exp_f32 v58, v58
    v_smfmac_f32_32x32x32_bf16 v[80:95], a[56:59], v[48:55], v9
    v_exp_f32 v59, v59
    v_exp_f32 v60, v60
    v_exp_f32 v61, v61
    v_smfmac_f32_16x16x64_bf16 a[0:3], v[12:15], v[48:55], v9
    ds_read_b128 a[44:47], v3 offset:13312
    v_exp_f32 v62, v62
    v_exp_f32 v63, v63
    v_mfma_f32_32x32x16_bf16 v[16:31], a[32:35], v[144:147], 0
    v_exp_f32 v64, v64
    v_exp_f32 v65, v65
    v_exp_f32 v66, v66
    v_mfma_f32_32x32x16_bf16 v[16:31], a[36:39], v[148:151], v[16:31]
    v_exp_f32 v67, v67
    v_exp_f32 v68, v68
    v_exp_f32 v69, v69
    v_smfmac_f32_32x32x32_bf16 v[80:95], a[60:63], v[56:63], v9
    v_exp_f32 v70, v70
    v_exp_f32 v71, v71
    v_exp_f32 v72, v72
    v_smfmac_f32_16x16x64_bf16 a[0:3], v[12:15], v[56:63], v9
    ds_read_b128 a[72:75], v3 offset:14336
    v_exp_f32 v73, v73
    v_exp_f32 v74, v74
    v_smfmac_f32_32x32x32_bf16 v[96:111], a[56:59], v[64:71], v9
    v_exp_f32 v75, v75
    v_exp_f32 v76, v76
    v_exp_f32 v77, v77
    v_smfmac_f32_16x16x64_bf16 a[4:7], v[12:15], v[64:71], v9
    ds_read_b128 a[76:79], v3 offset:15360
    v_exp_f32 v78, v78
    v_exp_f32 v79, v79
    v_mfma_f32_32x32x16_bf16 v[32:47], a[32:35], v[152:155], 0
    s_waitcnt lgkmcnt(2)
    v_exp_f32 v16, v16
    v_exp_f32 v17, v17
    v_exp_f32 v18, v18
    v_mfma_f32_32x32x16_bf16 v[32:47], a[36:39], v[156:159], v[32:47]
    v_exp_f32 v19, v19
    v_exp_f32 v20, v20
    v_exp_f32 v21, v21
    v_smfmac_f32_32x32x32_bf16 v[96:111], a[60:63], v[72:79], v9
    v_exp_f32 v22, v22
    v_exp_f32 v23, v23
    v_exp_f32 v24, v24
    v_smfmac_f32_16x16x64_bf16 a[4:7], v[12:15], v[72:79], v9
    ds_read_b128 a[16:19], v3 offset:16384
    v_exp_f32 v25, v25
    v_exp_f32 v26, v26
    v_smfmac_f32_32x32x32_bf16 v[80:95], a[64:67], v[16:23], v9
    v_exp_f32 v27, v27
    v_exp_f32 v28, v28
    v_exp_f32 v29, v29
    v_smfmac_f32_16x16x64_bf16 a[0:3], v[12:15], v[16:23], v9
    ds_read_b128 a[20:23], v3 offset:17408
    v_exp_f32 v30, v30
    v_exp_f32 v31, v31
    v_mfma_f32_32x32x16_bf16 v[48:63], a[40:43], v[144:147], 0
    v_exp_f32 v32, v32
    v_exp_f32 v33, v33
    v_exp_f32 v34, v34
    v_mfma_f32_32x32x16_bf16 v[48:63], a[44:47], v[148:151], v[48:63]
    v_exp_f32 v35, v35
    v_exp_f32 v36, v36
    v_exp_f32 v37, v37
    v_smfmac_f32_32x32x32_bf16 v[80:95], a[68:71], v[24:31], v9
    v_exp_f32 v38, v38
    v_exp_f32 v39, v39
    v_exp_f32 v40, v40
    v_smfmac_f32_16x16x64_bf16 a[0:3], v[12:15], v[24:31], v9
    ds_read_b128 a[48:51], v3 offset:18432
    v_exp_f32 v41, v41
    v_exp_f32 v42, v42
    v_smfmac_f32_32x32x32_bf16 v[96:111], a[64:67], v[32:39], v9
    v_exp_f32 v43, v43
    v_exp_f32 v44, v44
    v_exp_f32 v45, v45
    v_smfmac_f32_16x16x64_bf16 a[4:7], v[12:15], v[32:39], v9
    ds_read_b128 a[52:55], v3 offset:19456
    v_exp_f32 v46, v46
    v_exp_f32 v47, v47
    v_mfma_f32_32x32x16_bf16 v[64:79], a[40:43], v[152:155], 0
    s_waitcnt lgkmcnt(2)
    v_exp_f32 v48, v48
    v_exp_f32 v49, v49
    v_exp_f32 v50, v50
    v_mfma_f32_32x32x16_bf16 v[64:79], a[44:47], v[156:159], v[64:79]
    v_exp_f32 v51, v51
    v_exp_f32 v52, v52
    v_exp_f32 v53, v53
    v_smfmac_f32_32x32x32_bf16 v[96:111], a[68:71], v[40:47], v9
    v_exp_f32 v54, v54
    v_exp_f32 v55, v55
    v_exp_f32 v56, v56
    v_smfmac_f32_16x16x64_bf16 a[4:7], v[12:15], v[40:47], v9
    ds_read_b128 a[24:27], v3 offset:20480
    v_exp_f32 v57, v57
    v_exp_f32 v58, v58
    v_smfmac_f32_32x32x32_bf16 v[80:95], a[72:75], v[48:55], v9
    v_exp_f32 v59, v59
    v_exp_f32 v60, v60
    v_exp_f32 v61, v61
    v_smfmac_f32_16x16x64_bf16 a[0:3], v[12:15], v[48:55], v9
    ds_read_b128 a[28:31], v3 offset:21504
    v_exp_f32 v62, v62
    v_exp_f32 v63, v63
    v_mfma_f32_32x32x16_bf16 v[16:31], a[16:19], v[144:147], 0
    v_exp_f32 v64, v64
    v_exp_f32 v65, v65
    v_exp_f32 v66, v66
    v_mfma_f32_32x32x16_bf16 v[16:31], a[20:23], v[148:151], v[16:31]
    v_exp_f32 v67, v67
    v_exp_f32 v68, v68
    v_exp_f32 v69, v69
    v_smfmac_f32_32x32x32_bf16 v[80:95], a[76:79], v[56:63], v9
    v_exp_f32 v70, v70
    v_exp_f32 v71, v71
    v_exp_f32 v72, v72
    v_smfmac_f32_16x16x64_bf16 a[0:3], v[12:15], v[56:63], v9
    ds_read_b128 a[56:59], v3 offset:22528
    v_exp_f32 v73, v73
    v_exp_f32 v74, v74
    v_smfmac_f32_32x32x32_bf16 v[96:111], a[72:75], v[64:71], v9
    v_exp_f32 v75, v75
    v_exp_f32 v76, v76
    v_exp_f32 v77, v77
    v_smfmac_f32_16x16x64_bf16 a[4:7], v[12:15], v[64:71], v9
    ds_read_b128 a[60:63], v3 offset:23552
    v_exp_f32 v78, v78
    v_exp_f32 v79, v79
    v_mfma_f32_32x32x16_bf16 v[32:47], a[16:19], v[152:155], 0
    s_waitcnt lgkmcnt(2)
    v_exp_f32 v16, v16
    v_exp_f32 v17, v17
    v_exp_f32 v18, v18
    v_mfma_f32_32x32x16_bf16 v[32:47], a[20:23], v[156:159], v[32:47]
    v_exp_f32 v19, v19
    v_exp_f32 v20, v20
    v_exp_f32 v21, v21
    v_smfmac_f32_32x32x32_bf16 v[96:111], a[76:79], v[72:79], v9
    v_exp_f32 v22, v22
    v_exp_f32 v23, v23
    v_exp_f32 v24, v24
    v_smfmac_f32_16x16x64_bf16 a[4:7], v[12:15], v[72:79], v9
    ds_read_b128 a[32:35], v3 offset:24576
    v_exp_f32 v25, v25
    v_exp_f32 v26, v26
    v_smfmac_f32_32x32x32_bf16 v[80:95], a[48:51], v[16:23], v9
    v_exp_f32 v27, v27
    v_exp_f32 v28, v28
    v_exp_f32 v29, v29
    v_smfmac_f32_16x16x64_bf16 a[0:3], v[12:15], v[16:23], v9
    ds_read_b128 a[36:39], v3 offset:25600
    v_exp_f32 v30, v30
    v_exp_f32 v31, v31
    v_mfma_f32_32x32x16_bf16 v[48:63], a[24:27], v[144:147], 0
    v_exp_f32 v32, v32
    v_exp_f32 v33, v33
    v_exp_f32 v34, v34
    v_mfma_f32_32x32x16_bf16 v[48:63], a[28:31], v[148:151], v[48:63]
    v_exp_f32 v35, v35
    v_exp_f32 v36, v36
    v_exp_f32 v37, v37
    v_smfmac_f32_32x32x32_bf16 v[80:95], a[52:55], v[24:31], v9
    v_exp_f32 v38, v38
    v_exp_f32 v39, v39
    v_exp_f32 v40, v40
    v_smfmac_f32_16x16x64_bf16 a[0:3], v[12:15], v[24:31], v9
    ds_read_b128 a[64:67], v3 offset:26624
    v_exp_f32 v41, v41
    v_exp_f32 v42, v42
    v_smfmac_f32_32x32x32_bf16 v[96:111], a[48:51], v[32:39], v9
    v_exp_f32 v43, v43
    v_exp_f32 v44, v44
    v_exp_f32 v45, v45
    v_smfmac_f32_16x16x64_bf16 a[4:7], v[12:15], v[32:39], v9
    ds_read_b128 a[68:71], v3 offset:27648
    v_exp_f32 v46, v46
    v_exp_f32 v47, v47
    v_mfma_f32_32x32x16_bf16 v[64:79], a[24:27], v[152:155], 0
    s_waitcnt lgkmcnt(2)
    v_exp_f32 v48, v48
    v_exp_f32 v49, v49
    v_exp_f32 v50, v50
    v_mfma_f32_32x32x16_bf16 v[64:79], a[28:31], v[156:159], v[64:79]
    v_exp_f32 v51, v51
    v_exp_f32 v52, v52
    v_exp_f32 v53, v53
    v_smfmac_f32_32x32x32_bf16 v[96:111], a[52:55], v[40:47], v9
    v_exp_f32 v54, v54
    v_exp_f32 v55, v55
    v_exp_f32 v56, v56
    v_smfmac_f32_16x16x64_bf16 a[4:7], v[12:15], v[40:47], v9
    ds_read_b128 a[40:43], v3 offset:28672
    v_exp_f32 v57, v57
    v_exp_f32 v58, v58
    v_smfmac_f32_32x32x32_bf16 v[80:95], a[56:59], v[48:55], v9
    v_exp_f32 v59, v59
    v_exp_f32 v60, v60
    v_exp_f32 v61, v61
    v_smfmac_f32_16x16x64_bf16 a[0:3], v[12:15], v[48:55], v9
    ds_read_b128 a[44:47], v3 offset:29696
    v_exp_f32 v62, v62
    v_exp_f32 v63, v63
    v_mfma_f32_32x32x16_bf16 v[16:31], a[32:35], v[144:147], 0
    v_exp_f32 v64, v64
    v_exp_f32 v65, v65
    v_exp_f32 v66, v66
    v_mfma_f32_32x32x16_bf16 v[16:31], a[36:39], v[148:151], v[16:31]
    v_exp_f32 v67, v67
    v_exp_f32 v68, v68
    v_exp_f32 v69, v69
    v_smfmac_f32_32x32x32_bf16 v[80:95], a[60:63], v[56:63], v9
    v_exp_f32 v70, v70
    v_exp_f32 v71, v71
    v_exp_f32 v72, v72
    v_smfmac_f32_16x16x64_bf16 a[0:3], v[12:15], v[56:63], v9
    ds_read_b128 a[72:75], v3 offset:30720
    v_exp_f32 v73, v73
    v_exp_f32 v74, v74
    v_smfmac_f32_32x32x32_bf16 v[96:111], a[56:59], v[64:71], v9
    v_exp_f32 v75, v75
    v_exp_f32 v76, v76
    v_exp_f32 v77, v77
    v_smfmac_f32_16x16x64_bf16 a[4:7], v[12:15], v[64:71], v9
    ds_read_b128 a[76:79], v3 offset:31744
    v_exp_f32 v78, v78
    v_exp_f32 v79, v79
    v_mfma_f32_32x32x16_bf16 v[32:47], a[32:35], v[152:155], 0
    s_waitcnt lgkmcnt(2)
    v_exp_f32 v16, v16
    v_exp_f32 v17, v17
    v_exp_f32 v18, v18
    v_mfma_f32_32x32x16_bf16 v[32:47], a[36:39], v[156:159], v[32:47]
    v_exp_f32 v19, v19
    v_exp_f32 v20, v20
    v_exp_f32 v21, v21
    v_smfmac_f32_32x32x32_bf16 v[96:111], a[60:63], v[72:79], v9
    v_exp_f32 v22, v22
    v_exp_f32 v23, v23
    v_exp_f32 v24, v24
    v_smfmac_f32_16x16x64_bf16 a[4:7], v[12:15], v[72:79], v9
    ds_read_b128 a[16:19], v3 offset:32768
    v_exp_f32 v25, v25
    v_exp_f32 v26, v26
    v_smfmac_f32_32x32x32_bf16 v[80:95], a[64:67], v[16:23], v9
    v_exp_f32 v27, v27
    v_exp_f32 v28, v28
    v_exp_f32 v29, v29
    v_smfmac_f32_16x16x64_bf16 a[0:3], v[12:15], v[16:23], v9
    ds_read_b128 a[20:23], v3 offset:33792
    v_exp_f32 v30, v30
    v_exp_f32 v31, v31
    v_mfma_f32_32x32x16_bf16 v[48:63], a[40:43], v[144:147], 0
    v_exp_f32 v32, v32
    v_exp_f32 v33, v33
    v_exp_f32 v34, v34
    v_mfma_f32_32x32x16_bf16 v[48:63], a[44:47], v[148:151], v[48:63]
    v_exp_f32 v35, v35
    v_exp_f32 v36, v36
    v_exp_f32 v37, v37
    v_smfmac_f32_32x32x32_bf16 v[80:95], a[68:71], v[24:31], v9
    v_exp_f32 v38, v38
    v_exp_f32 v39, v39
    v_exp_f32 v40, v40
    v_smfmac_f32_16x16x64_bf16 a[0:3], v[12:15], v[24:31], v9
    ds_read_b128 a[48:51], v3 offset:34816
    v_exp_f32 v41, v41
    v_exp_f32 v42, v42
    v_smfmac_f32_32x32x32_bf16 v[96:111], a[64:67], v[32:39], v9
    v_exp_f32 v43, v43
    v_exp_f32 v44, v44
    v_exp_f32 v45, v45
    v_smfmac_f32_16x16x64_bf16 a[4:7], v[12:15], v[32:39], v9
    ds_read_b128 a[52:55], v3 offset:35840
    v_exp_f32 v46, v46
    v_exp_f32 v47, v47
    v_mfma_f32_32x32x16_bf16 v[64:79], a[40:43], v[152:155], 0
    s_waitcnt lgkmcnt(2)
    v_exp_f32 v48, v48
    v_exp_f32 v49, v49
    v_exp_f32 v50, v50
    v_mfma_f32_32x32x16_bf16 v[64:79], a[44:47], v[156:159], v[64:79]
    v_exp_f32 v51, v51
    v_exp_f32 v52, v52
    v_exp_f32 v53, v53
    v_smfmac_f32_32x32x32_bf16 v[96:111], a[68:71], v[40:47], v9
    v_exp_f32 v54, v54
    v_exp_f32 v55, v55
    v_exp_f32 v56, v56
    v_smfmac_f32_16x16x64_bf16 a[4:7], v[12:15], v[40:47], v9
    ds_read_b128 a[24:27], v3 offset:36864
    v_exp_f32 v57, v57
    v_exp_f32 v58, v58
    v_smfmac_f32_32x32x32_bf16 v[80:95], a[72:75], v[48:55], v9
    v_exp_f32 v59, v59
    v_exp_f32 v60, v60
    v_exp_f32 v61, v61
    v_smfmac_f32_16x16x64_bf16 a[0:3], v[12:15], v[48:55], v9
    ds_read_b128 a[28:31], v3 offset:37888
    v_exp_f32 v62, v62
    v_exp_f32 v63, v63
    v_mfma_f32_32x32x16_bf16 v[16:31], a[16:19], v[160:163], 0
    v_exp_f32 v64, v64
    v_exp_f32 v65, v65
    v_exp_f32 v66, v66
    v_mfma_f32_32x32x16_bf16 v[16:31], a[20:23], v[164:167], v[16:31]
    v_exp_f32 v67, v67
    v_exp_f32 v68, v68
    v_exp_f32 v69, v69
    v_smfmac_f32_32x32x32_bf16 v[80:95], a[76:79], v[56:63], v9
    v_exp_f32 v70, v70
    v_exp_f32 v71, v71
    v_exp_f32 v72, v72
    v_smfmac_f32_16x16x64_bf16 a[0:3], v[12:15], v[56:63], v9
    ds_read_b128 a[56:59], v3 offset:38912
    v_exp_f32 v73, v73
    v_exp_f32 v74, v74
    v_smfmac_f32_32x32x32_bf16 v[96:111], a[72:75], v[64:71], v9
    v_exp_f32 v75, v75
    v_exp_f32 v76, v76
    v_exp_f32 v77, v77
    v_smfmac_f32_16x16x64_bf16 a[4:7], v[12:15], v[64:71], v9
    ds_read_b128 a[60:63], v3 offset:39936
    v_exp_f32 v78, v78
    v_exp_f32 v79, v79
    v_accvgpr_read_b32 v0, a0
    v_rcp_f32 v8, v0
    v_min_f32 v4, v4, v0
    v_max_f32 v5, v5, v0
    v_fma_f32 v6, v0, 0, v6
    v_mul_f32 v8, v8, v10
    v_pk_mul_f32 v[80:81], v[80:81], v[8:9] op_sel_hi:[1,0]
    v_pk_mul_f32 v[82:83], v[82:83], v[8:9] op_sel_hi:[1,0]
    v_pk_mul_f32 v[84:85], v[84:85], v[8:9] op_sel_hi:[1,0]
    v_pk_mul_f32 v[86:87], v[86:87], v[8:9] op_sel_hi:[1,0]
    v_pk_fma_f32 v[6:7], v[80:81], 0, v[6:7]
    v_pk_fma_f32 v[6:7], v[82:83], 0, v[6:7]
    v_pk_fma_f32 v[6:7], v[84:85], 0, v[6:7]
    v_pk_fma_f32 v[6:7], v[86:87], 0, v[6:7]
    v_cvt_pk_bf16_f32 v80, v80, v81
    v_cvt_pk_bf16_f32 v81, v82, v83
    v_cvt_pk_bf16_f32 v82, v84, v85
    v_cvt_pk_bf16_f32 v83, v86, v87
    buffer_store_dwordx4 v[80:83], v1, s[16:19], s50 offen offset:0 sc1
    v_pk_mul_f32 v[88:89], v[88:89], v[8:9] op_sel_hi:[1,0]
    v_pk_mul_f32 v[90:91], v[90:91], v[8:9] op_sel_hi:[1,0]
    v_pk_mul_f32 v[92:93], v[92:93], v[8:9] op_sel_hi:[1,0]
    v_pk_mul_f32 v[94:95], v[94:95], v[8:9] op_sel_hi:[1,0]
    v_pk_fma_f32 v[6:7], v[88:89], 0, v[6:7]
    v_pk_fma_f32 v[6:7], v[90:91], 0, v[6:7]
    v_pk_fma_f32 v[6:7], v[92:93], 0, v[6:7]
    v_pk_fma_f32 v[6:7], v[94:95], 0, v[6:7]
    v_cvt_pk_bf16_f32 v88, v88, v89
    v_cvt_pk_bf16_f32 v89, v90, v91
    v_cvt_pk_bf16_f32 v90, v92, v93
    v_cvt_pk_bf16_f32 v91, v94, v95
    buffer_store_dwordx4 v[88:91], v1, s[16:19], s50 offen offset:512 sc1
    v_mfma_f32_32x32x16_bf16 v[32:47], a[16:19], v[168:171], 0
    s_waitcnt lgkmcnt(2)
    v_exp_f32 v16, v16
    v_exp_f32 v17, v17
    v_exp_f32 v18, v18
    v_mfma_f32_32x32x16_bf16 v[32:47], a[20:23], v[172:175], v[32:47]
    v_exp_f32 v19, v19
    v_exp_f32 v20, v20
    v_exp_f32 v21, v21
    v_smfmac_f32_32x32x32_bf16 v[96:111], a[76:79], v[72:79], v9
    v_exp_f32 v22, v22
    v_exp_f32 v23, v23
    v_exp_f32 v24, v24
    v_smfmac_f32_16x16x64_bf16 a[4:7], v[12:15], v[72:79], v9
    ds_read_b128 a[32:35], v3 offset:40960
    v_exp_f32 v25, v25
    v_exp_f32 v26, v26
    v_smfmac_f32_32x32x32_bf16 v[112:127], a[48:51], v[16:23], v9
    v_exp_f32 v27, v27
    v_exp_f32 v28, v28
    v_exp_f32 v29, v29
    v_smfmac_f32_16x16x64_bf16 a[8:11], v[12:15], v[16:23], v9
    ds_read_b128 a[36:39], v3 offset:41984
    v_exp_f32 v30, v30
    v_exp_f32 v31, v31
    v_accvgpr_read_b32 v0, a4
    v_rcp_f32 v8, v0
    v_min_f32 v4, v4, v0
    v_max_f32 v5, v5, v0
    v_fma_f32 v6, v0, 0, v6
    v_mul_f32 v8, v8, v11
    v_pk_mul_f32 v[96:97], v[96:97], v[8:9] op_sel_hi:[1,0]
    v_pk_mul_f32 v[98:99], v[98:99], v[8:9] op_sel_hi:[1,0]
    v_pk_mul_f32 v[100:101], v[100:101], v[8:9] op_sel_hi:[1,0]
    v_pk_mul_f32 v[102:103], v[102:103], v[8:9] op_sel_hi:[1,0]
    v_pk_fma_f32 v[6:7], v[96:97], 0, v[6:7]
    v_pk_fma_f32 v[6:7], v[98:99], 0, v[6:7]
    v_pk_fma_f32 v[6:7], v[100:101], 0, v[6:7]
    v_pk_fma_f32 v[6:7], v[102:103], 0, v[6:7]
    v_cvt_pk_bf16_f32 v96, v96, v97
    v_cvt_pk_bf16_f32 v97, v98, v99
    v_cvt_pk_bf16_f32 v98, v100, v101
    v_cvt_pk_bf16_f32 v99, v102, v103
    buffer_store_dwordx4 v[96:99], v1, s[16:19], s51 offen offset:0 sc1
    v_pk_mul_f32 v[104:105], v[104:105], v[8:9] op_sel_hi:[1,0]
    v_pk_mul_f32 v[106:107], v[106:107], v[8:9] op_sel_hi:[1,0]
    v_pk_mul_f32 v[108:109], v[108:109], v[8:9] op_sel_hi:[1,0]
    v_pk_mul_f32 v[110:111], v[110:111], v[8:9] op_sel_hi:[1,0]
    v_pk_fma_f32 v[6:7], v[104:105], 0, v[6:7]
    v_pk_fma_f32 v[6:7], v[106:107], 0, v[6:7]
    v_pk_fma_f32 v[6:7], v[108:109], 0, v[6:7]
    v_pk_fma_f32 v[6:7], v[110:111], 0, v[6:7]
    v_cvt_pk_bf16_f32 v104, v104, v105
    v_cvt_pk_bf16_f32 v105, v106, v107
    v_cvt_pk_bf16_f32 v106, v108, v109
    v_cvt_pk_bf16_f32 v107, v110, v111
    buffer_store_dwordx4 v[104:107], v1, s[16:19], s51 offen offset:512 sc1
    v_cmp_gt_f32 vcc, 0x37800000, v4
    s_mov_b32 s29, 0x5f800000
    v_cmp_lt_f32 s[46:47], s29, v5
    v_cmp_u_f32 s[30:31], v6, v7
    s_nop 1
    s_or_b64 s[46:47], s[46:47], vcc
    s_or_b64 s[46:47], s[46:47], s[30:31]
    s_cselect_b32 s54, 1, 0
    s_cbranch_scc1 AT_SLOW
    v_mfma_f32_32x32x16_bf16 v[48:63], a[24:27], v[160:163], 0
    v_exp_f32 v32, v32
    v_exp_f32 v33, v33
    v_exp_f32 v34, v34
    v_mfma_f32_32x32x16_bf16 v[48:63], a[28:31], v[164:167], v[48:63]
    v_exp_f32 v35, v35
    v_exp_f32 v36, v36
    v_exp_f32 v37, v37
    v_smfmac_f32_32x32x32_bf16 v[112:127], a[52:55], v[24:31], v9
    v_exp_f32 v38, v38
    v_exp_f32 v39, v39
    v_exp_f32 v40, v40
    v_smfmac_f32_16x16x64_bf16 a[8:11], v[12:15], v[24:31], v9
    ds_read_b128 a[64:67], v3 offset:43008
    v_exp_f32 v41, v41
    v_exp_f32 v42, v42
    v_smfmac_f32_32x32x32_bf16 v[128:143], a[48:51], v[32:39], v9
    v_exp_f32 v43, v43
    v_exp_f32 v44, v44
    v_exp_f32 v45, v45
    v_smfmac_f32_16x16x64_bf16 a[12:15], v[12:15], v[32:39], v9
    ds_read_b128 a[68:71], v3 offset:44032
    v_exp_f32 v46, v46
    v_exp_f32 v47, v47
    v_mfma_f32_32x32x16_bf16 v[64:79], a[24:27], v[168:171], 0
    s_waitcnt lgkmcnt(2)
    v_exp_f32 v48, v48
    v_exp_f32 v49, v49
    v_exp_f32 v50, v50
    v_mfma_f32_32x32x16_bf16 v[64:79], a[28:31], v[172:175], v[64:79]
    v_exp_f32 v51, v51
    v_exp_f32 v52, v52
    v_exp_f32 v53, v53
    v_smfmac_f32_32x32x32_bf16 v[128:143], a[52:55], v[40:47], v9
    v_exp_f32 v54, v54
    v_exp_f32 v55, v55
    v_exp_f32 v56, v56
    v_smfmac_f32_16x16x64_bf16 a[12:15], v[12:15], v[40:47], v9
    ds_read_b128 a[40:43], v3 offset:45056
    v_exp_f32 v57, v57
    v_exp_f32 v58, v58
    v_smfmac_f32_32x32x32_bf16 v[112:127], a[56:59], v[48:55], v9
    v_exp_f32 v59, v59
    v_exp_f32 v60, v60
    v_exp_f32 v61, v61
    v_smfmac_f32_16x16x64_bf16 a[8:11], v[12:15], v[48:55], v9
    ds_read_b128 a[44:47], v3 offset:46080
    v_exp_f32 v62, v62
    v_exp_f32 v63, v63
    v_mfma_f32_32x32x16_bf16 v[16:31], a[32:35], v[160:163], 0
    v_exp_f32 v64, v64
    v_exp_f32 v65, v65
    v_exp_f32 v66, v66
    v_mfma_f32_32x32x16_bf16 v[16:31], a[36:39], v[164:167], v[16:31]
    v_exp_f32 v67, v67
    v_exp_f32 v68, v68
    v_exp_f32 v69, v69
    v_smfmac_f32_32x32x32_bf16 v[112:127], a[60:63], v[56:63], v9
    v_exp_f32 v70, v70
    v_exp_f32 v71, v71
    v_exp_f32 v72, v72
    v_smfmac_f32_16x16x64_bf16 a[8:11], v[12:15], v[56:63], v9
    ds_read_b128 a[72:75], v3 offset:47104
    v_exp_f32 v73, v73
    v_exp_f32 v74, v74
    v_smfmac_f32_32x32x32_bf16 v[128:143], a[56:59], v[64:71], v9
    v_exp_f32 v75, v75
    v_exp_f32 v76, v76
    v_exp_f32 v77, v77
    v_smfmac_f32_16x16x64_bf16 a[12:15], v[12:15], v[64:71], v9
    ds_read_b128 a[76:79], v3 offset:48128
    v_exp_f32 v78, v78
    v_exp_f32 v79, v79
    v_mfma_f32_32x32x16_bf16 v[32:47], a[32:35], v[168:171], 0
    s_waitcnt lgkmcnt(2)
    v_exp_f32 v16, v16
    v_exp_f32 v17, v17
    v_exp_f32 v18, v18
    v_mfma_f32_32x32x16_bf16 v[32:47], a[36:39], v[172:175], v[32:47]
    v_exp_f32 v19, v19
    v_exp_f32 v20, v20
    v_exp_f32 v21, v21
    v_smfmac_f32_32x32x32_bf16 v[128:143], a[60:63], v[72:79], v9
    v_exp_f32 v22, v22
    v_exp_f32 v23, v23
    v_exp_f32 v24, v24
    v_smfmac_f32_16x16x64_bf16 a[12:15], v[12:15], v[72:79], v9
    ds_read_b128 a[16:19], v3 offset:49152
    v_exp_f32 v25, v25
    v_exp_f32 v26, v26
    v_smfmac_f32_32x32x32_bf16 v[112:127], a[64:67], v[16:23], v9
    v_exp_f32 v27, v27
    v_exp_f32 v28, v28
    v_exp_f32 v29, v29
    v_smfmac_f32_16x16x64_bf16 a[8:11], v[12:15], v[16:23], v9
    ds_read_b128 a[20:23], v3 offset:50176
    v_exp_f32 v30, v30
    v_exp_f32 v31, v31
    v_mfma_f32_32x32x16_bf16 v[48:63], a[40:43], v[160:163], 0
    v_exp_f32 v32, v32
    v_exp_f32 v33, v33
    v_exp_f32 v34, v34
    v_mfma_f32_32x32x16_bf16 v[48:63], a[44:47], v[164:167], v[48:63]
    v_exp_f32 v35, v35
    v_exp_f32 v36, v36
    v_exp_f32 v37, v37
    v_smfmac_f32_32x32x32_bf16 v[112:127], a[68:71], v[24:31], v9
    v_exp_f32 v38, v38
    v_exp_f32 v39, v39
    v_exp_f32 v40, v40
    v_smfmac_f32_16x16x64_bf16 a[8:11], v[12:15], v[24:31], v9
    ds_read_b128 a[48:51], v3 offset:51200
    v_exp_f32 v41, v41
    v_exp_f32 v42, v42
    v_smfmac_f32_32x32x32_bf16 v[128:143], a[64:67], v[32:39], v9
    v_exp_f32 v43, v43
    v_exp_f32 v44, v44
    v_exp_f32 v45, v45
    v_smfmac_f32_16x16x64_bf16 a[12:15], v[12:15], v[32:39], v9
    ds_read_b128 a[52:55], v3 offset:52224
    v_exp_f32 v46, v46
    v_exp_f32 v47, v47
    s_waitcnt vmcnt(0)
    v_mov_b32 v8, 0
    v_mov_b32 v0, 1
    s_mov_b64 exec, 1
    buffer_atomic_add v0, v8, s[16:19], s55 offen offset:0 sc1
    s_mov_b64 exec, -1
    v_mfma_f32_32x32x16_bf16 v[64:79], a[40:43], v[168:171], 0
    s_waitcnt lgkmcnt(2)
    v_exp_f32 v48, v48
    v_exp_f32 v49, v49
    v_exp_f32 v50, v50
    v_mfma_f32_32x32x16_bf16 v[64:79], a[44:47], v[172:175], v[64:79]
    v_exp_f32 v51, v51
    v_exp_f32 v52, v52
    v_exp_f32 v53, v53
    v_smfmac_f32_32x32x32_bf16 v[128:143], a[68:71], v[40:47], v9
    v_exp_f32 v54, v54
    v_exp_f32 v55, v55
    v_exp_f32 v56, v56
    v_smfmac_f32_16x16x64_bf16 a[12:15], v[12:15], v[40:47], v9
    ds_read_b128 a[24:27], v3 offset:53248
    v_exp_f32 v57, v57
    v_exp_f32 v58, v58
    v_smfmac_f32_32x32x32_bf16 v[112:127], a[72:75], v[48:55], v9
    v_exp_f32 v59, v59
    v_exp_f32 v60, v60
    v_exp_f32 v61, v61
    v_smfmac_f32_16x16x64_bf16 a[8:11], v[12:15], v[48:55], v9
    ds_read_b128 a[28:31], v3 offset:54272
    v_exp_f32 v62, v62
    v_exp_f32 v63, v63
    v_mfma_f32_32x32x16_bf16 v[16:31], a[16:19], v[160:163], 0
    v_exp_f32 v64, v64
    v_exp_f32 v65, v65
    v_exp_f32 v66, v66
    v_mfma_f32_32x32x16_bf16 v[16:31], a[20:23], v[164:167], v[16:31]
    v_exp_f32 v67, v67
    v_exp_f32 v68, v68
    v_exp_f32 v69, v69
    v_smfmac_f32_32x32x32_bf16 v[112:127], a[76:79], v[56:63], v9
    v_exp_f32 v70, v70
    v_exp_f32 v71, v71
    v_exp_f32 v72, v72
    v_smfmac_f32_16x16x64_bf16 a[8:11], v[12:15], v[56:63], v9
    ds_read_b128 a[56:59], v3 offset:55296
    v_exp_f32 v73, v73
    v_exp_f32 v74, v74
    v_smfmac_f32_32x32x32_bf16 v[128:143], a[72:75], v[64:71], v9
    v_exp_f32 v75, v75
    v_exp_f32 v76, v76
    v_exp_f32 v77, v77
    v_smfmac_f32_16x16x64_bf16 a[12:15], v[12:15], v[64:71], v9
    ds_read_b128 a[60:63], v3 offset:56320
    v_exp_f32 v78, v78
    v_exp_f32 v79, v79
    v_mfma_f32_32x32x16_bf16 v[32:47], a[16:19], v[168:171], 0
    s_waitcnt lgkmcnt(2)
    v_exp_f32 v16, v16
    v_exp_f32 v17, v17
    v_exp_f32 v18, v18
    v_mfma_f32_32x32x16_bf16 v[32:47], a[20:23], v[172:175], v[32:47]
    v_exp_f32 v19, v19
    v_exp_f32 v20, v20
    v_exp_f32 v21, v21
    v_smfmac_f32_32x32x32_bf16 v[128:143], a[76:79], v[72:79], v9
    v_exp_f32 v22, v22
    v_exp_f32 v23, v23
    v_exp_f32 v24, v24
    v_smfmac_f32_16x16x64_bf16 a[12:15], v[12:15], v[72:79], v9
    ds_read_b128 a[32:35], v3 offset:57344
    v_exp_f32 v25, v25
    v_exp_f32 v26, v26
    v_smfmac_f32_32x32x32_bf16 v[112:127], a[48:51], v[16:23], v9
    v_exp_f32 v27, v27
    v_exp_f32 v28, v28
    v_exp_f32 v29, v29
    v_smfmac_f32_16x16x64_bf16 a[8:11], v[12:15], v[16:23], v9
    ds_read_b128 a[36:39], v3 offset:58368
    v_exp_f32 v30, v30
    v_exp_f32 v31, v31
    v_mfma_f32_32x32x16_bf16 v[48:63], a[24:27], v[160:163], 0
    v_exp_f32 v32, v32
    v_exp_f32 v33, v33
    v_exp_f32 v34, v34
    v_mfma_f32_32x32x16_bf16 v[48:63], a[28:31], v[164:167], v[48:63]
    v_exp_f32 v35, v35
    v_exp_f32 v36, v36
    v_exp_f32 v37, v37
    v_smfmac_f32_32x32x32_bf16 v[112:127], a[52:55], v[24:31], v9
    v_exp_f32 v38, v38
    v_exp_f32 v39, v39
    v_exp_f32 v40, v40
    v_smfmac_f32_16x16x64_bf16 a[8:11], v[12:15], v[24:31], v9
    ds_read_b128 a[64:67], v3 offset:59392
    v_exp_f32 v41, v41
    v_exp_f32 v42, v42
    v_smfmac_f32_32x32x32_bf16 v[128:143], a[48:51], v[32:39], v9
    v_exp_f32 v43, v43
    v_exp_f32 v44, v44
    v_exp_f32 v45, v45
    v_smfmac_f32_16x16x64_bf16 a[12:15], v[12:15], v[32:39], v9
    ds_read_b128 a[68:71], v3 offset:60416
    v_exp_f32 v46, v46
    v_exp_f32 v47, v47
    v_mfma_f32_32x32x16_bf16 v[64:79], a[24:27], v[168:171], 0
    s_waitcnt lgkmcnt(2)
    v_exp_f32 v48, v48
    v_exp_f32 v49, v49
    v_exp_f32 v50, v50
    v_mfma_f32_32x32x16_bf16 v[64:79], a[28:31], v[172:175], v[64:79]
    v_exp_f32 v51, v51
    v_exp_f32 v52, v52
    v_exp_f32 v53, v53
    v_smfmac_f32_32x32x32_bf16 v[128:143], a[52:55], v[40:47], v9
    v_exp_f32 v54, v54
    v_exp_f32 v55, v55
    v_exp_f32 v56, v56
    v_smfmac_f32_16x16x64_bf16 a[12:15], v[12:15], v[40:47], v9
    ds_read_b128 a[40:43], v3 offset:61440
    v_exp_f32 v57, v57
    v_exp_f32 v58, v58
    v_smfmac_f32_32x32x32_bf16 v[112:127], a[56:59], v[48:55], v9
    v_exp_f32 v59, v59
    v_exp_f32 v60, v60
    v_exp_f32 v61, v61
    v_smfmac_f32_16x16x64_bf16 a[8:11], v[12:15], v[48:55], v9
    ds_read_b128 a[44:47], v3 offset:62464
    v_exp_f32 v62, v62
    v_exp_f32 v63, v63
    v_mfma_f32_32x32x16_bf16 v[16:31], a[32:35], v[160:163], 0
    v_exp_f32 v64, v64
    v_exp_f32 v65, v65
    v_exp_f32 v66, v66
    v_mfma_f32_32x32x16_bf16 v[16:31], a[36:39], v[164:167], v[16:31]
    v_exp_f32 v67, v67
    v_exp_f32 v68, v68
    v_exp_f32 v69, v69
    v_smfmac_f32_32x32x32_bf16 v[112:127], a[60:63], v[56:63], v9
    v_exp_f32 v70, v70
    v_exp_f32 v71, v71
    v_exp_f32 v72, v72
    v_smfmac_f32_16x16x64_bf16 a[8:11], v[12:15], v[56:63], v9
    ds_read_b128 a[72:75], v3 offset:63488
    v_exp_f32 v73, v73
    v_exp_f32 v74, v74
    v_smfmac_f32_32x32x32_bf16 v[128:143], a[56:59], v[64:71], v9
    v_exp_f32 v75, v75
    v_exp_f32 v76, v76
    v_exp_f32 v77, v77
    v_smfmac_f32_16x16x64_bf16 a[12:15], v[12:15], v[64:71], v9
    ds_read_b128 a[76:79], v3 offset:64512
    v_exp_f32 v78, v78
    v_exp_f32 v79, v79
    v_mfma_f32_32x32x16_bf16 v[32:47], a[32:35], v[168:171], 0
    s_waitcnt lgkmcnt(2)
    v_exp_f32 v16, v16
    v_exp_f32 v17, v17
    v_exp_f32 v18, v18
    v_mfma_f32_32x32x16_bf16 v[32:47], a[36:39], v[172:175], v[32:47]
    v_exp_f32 v19, v19
    v_exp_f32 v20, v20
    v_exp_f32 v21, v21
    v_smfmac_f32_32x32x32_bf16 v[128:143], a[60:63], v[72:79], v9
    v_exp_f32 v22, v22
    v_exp_f32 v23, v23
    v_exp_f32 v24, v24
    v_smfmac_f32_16x16x64_bf16 a[12:15], v[12:15], v[72:79], v9
    ds_read_b128 a[16:19], v3 offset:0
    v_exp_f32 v25, v25
    v_exp_f32 v26, v26
    v_smfmac_f32_32x32x32_bf16 v[112:127], a[64:67], v[16:23], v9
    v_exp_f32 v27, v27
    v_exp_f32 v28, v28
    v_exp_f32 v29, v29
    v_smfmac_f32_16x16x64_bf16 a[8:11], v[12:15], v[16:23], v9
    ds_read_b128 a[20:23], v3 offset:1024
    v_exp_f32 v30, v30
    v_exp_f32 v31, v31
    v_mfma_f32_32x32x16_bf16 v[48:63], a[40:43], v[160:163], 0
    v_exp_f32 v32, v32
    v_exp_f32 v33, v33
    v_exp_f32 v34, v34
    v_mfma_f32_32x32x16_bf16 v[48:63], a[44:47], v[164:167], v[48:63]
    v_exp_f32 v35, v35
    v_exp_f32 v36, v36
    v_exp_f32 v37, v37
    v_smfmac_f32_32x32x32_bf16 v[112:127], a[68:71], v[24:31], v9
    v_exp_f32 v38, v38
    v_exp_f32 v39, v39
    v_exp_f32 v40, v40
    v_smfmac_f32_16x16x64_bf16 a[8:11], v[12:15], v[24:31], v9
    ds_read_b128 a[48:51], v3 offset:2048
    v_exp_f32 v41, v41
    v_exp_f32 v42, v42
    v_smfmac_f32_32x32x32_bf16 v[128:143], a[64:67], v[32:39], v9
    v_exp_f32 v43, v43
    v_exp_f32 v44, v44
    v_exp_f32 v45, v45
    v_smfmac_f32_16x16x64_bf16 a[12:15], v[12:15], v[32:39], v9
    ds_read_b128 a[52:55], v3 offset:3072
    v_exp_f32 v46, v46
    v_exp_f32 v47, v47
    v_mfma_f32_32x32x16_bf16 v[64:79], a[40:43], v[168:171], 0
    s_waitcnt lgkmcnt(2)
    v_exp_f32 v48, v48
    v_exp_f32 v49, v49
    v_exp_f32 v50, v50
    v_mfma_f32_32x32x16_bf16 v[64:79], a[44:47], v[172:175], v[64:79]
    v_exp_f32 v51, v51
    v_exp_f32 v52, v52
    v_exp_f32 v53, v53
    v_smfmac_f32_32x32x32_bf16 v[128:143], a[68:71], v[40:47], v9
    v_exp_f32 v54, v54
    v_exp_f32 v55, v55
    v_exp_f32 v56, v56
    v_smfmac_f32_16x16x64_bf16 a[12:15], v[12:15], v[40:47], v9
    ds_read_b128 a[24:27], v3 offset:4096
    v_exp_f32 v57, v57
    v_exp_f32 v58, v58
    v_smfmac_f32_32x32x32_bf16 v[112:127], a[72:75], v[48:55], v9
    v_exp_f32 v59, v59
    v_exp_f32 v60, v60
    v_exp_f32 v61, v61
    v_smfmac_f32_16x16x64_bf16 a[8:11], v[12:15], v[48:55], v9
    ds_read_b128 a[28:31], v3 offset:5120
    v_exp_f32 v62, v62
    v_exp_f32 v63, v63
    v_mfma_f32_32x32x16_bf16 v[16:31], a[16:19], v[160:163], 0
    v_exp_f32 v64, v64
    v_exp_f32 v65, v65
    v_exp_f32 v66, v66
    v_mfma_f32_32x32x16_bf16 v[16:31], a[20:23], v[164:167], v[16:31]
    v_exp_f32 v67, v67
    v_exp_f32 v68, v68
    v_exp_f32 v69, v69
    v_smfmac_f32_32x32x32_bf16 v[112:127], a[76:79], v[56:63], v9
    v_exp_f32 v70, v70
    v_exp_f32 v71, v71
    v_exp_f32 v72, v72
    v_smfmac_f32_16x16x64_bf16 a[8:11], v[12:15], v[56:63], v9
    ds_read_b128 a[56:59], v3 offset:6144
    v_exp_f32 v73, v73
    v_exp_f32 v74, v74
    v_smfmac_f32_32x32x32_bf16 v[128:143], a[72:75], v[64:71], v9
    v_exp_f32 v75, v75
    v_exp_f32 v76, v76
    v_exp_f32 v77, v77
    v_smfmac_f32_16x16x64_bf16 a[12:15], v[12:15], v[64:71], v9
    ds_read_b128 a[60:63], v3 offset:7168
    v_exp_f32 v78, v78
    v_exp_f32 v79, v79
    v_mfma_f32_32x32x16_bf16 v[32:47], a[16:19], v[168:171], 0
    s_waitcnt lgkmcnt(2)
    v_exp_f32 v16, v16
    v_exp_f32 v17, v17
    v_exp_f32 v18, v18
    v_mfma_f32_32x32x16_bf16 v[32:47], a[20:23], v[172:175], v[32:47]
    v_exp_f32 v19, v19
    v_exp_f32 v20, v20
    v_exp_f32 v21, v21
    v_smfmac_f32_32x32x32_bf16 v[128:143], a[76:79], v[72:79], v9
    v_exp_f32 v22, v22
    v_exp_f32 v23, v23
    v_exp_f32 v24, v24
    v_smfmac_f32_16x16x64_bf16 a[12:15], v[12:15], v[72:79], v9
    ds_read_b128 a[32:35], v3 offset:8192
    v_exp_f32 v25, v25
    v_exp_f32 v26, v26
    v_smfmac_f32_32x32x32_bf16 v[112:127], a[48:51], v[16:23], v9
    v_exp_f32 v27, v27
    v_exp_f32 v28, v28
    v_exp_f32 v29, v29
    v_smfmac_f32_16x16x64_bf16 a[8:11], v[12:15], v[16:23], v9
    ds_read_b128 a[36:39], v3 offset:9216
    v_exp_f32 v30, v30
    v_exp_f32 v31, v31
    v_mfma_f32_32x32x16_bf16 v[48:63], a[24:27], v[160:163], 0
    v_exp_f32 v32, v32
    v_exp_f32 v33, v33
    v_exp_f32 v34, v34
    v_mfma_f32_32x32x16_bf16 v[48:63], a[28:31], v[164:167], v[48:63]
    v_exp_f32 v35, v35
    v_exp_f32 v36, v36
    v_exp_f32 v37, v37
    v_smfmac_f32_32x32x32_bf16 v[112:127], a[52:55], v[24:31], v9
    v_exp_f32 v38, v38
    v_exp_f32 v39, v39
    v_exp_f32 v40, v40
    v_smfmac_f32_16x16x64_bf16 a[8:11], v[12:15], v[24:31], v9
    ds_read_b128 a[64:67], v3 offset:10240
    v_exp_f32 v41, v41
    v_exp_f32 v42, v42
    v_smfmac_f32_32x32x32_bf16 v[128:143], a[48:51], v[32:39], v9
    v_exp_f32 v43, v43
    v_exp_f32 v44, v44
    v_exp_f32 v45, v45
    v_smfmac_f32_16x16x64_bf16 a[12:15], v[12:15], v[32:39], v9
    ds_read_b128 a[68:71], v3 offset:11264
    v_exp_f32 v46, v46
    v_exp_f32 v47, v47
    v_mfma_f32_32x32x16_bf16 v[64:79], a[24:27], v[168:171], 0
    s_waitcnt lgkmcnt(2)
    v_exp_f32 v48, v48
    v_exp_f32 v49, v49
    v_exp_f32 v50, v50
    v_mfma_f32_32x32x16_bf16 v[64:79], a[28:31], v[172:175], v[64:79]
    v_exp_f32 v51, v51
    v_exp_f32 v52, v52
    v_exp_f32 v53, v53
    v_smfmac_f32_32x32x32_bf16 v[128:143], a[52:55], v[40:47], v9
    v_exp_f32 v54, v54
    v_exp_f32 v55, v55
    v_exp_f32 v56, v56
    v_smfmac_f32_16x16x64_bf16 a[12:15], v[12:15], v[40:47], v9
    ds_read_b128 a[40:43], v3 offset:12288
    v_exp_f32 v57, v57
    v_exp_f32 v58, v58
    v_smfmac_f32_32x32x32_bf16 v[112:127], a[56:59], v[48:55], v9
    v_exp_f32 v59, v59
    v_exp_f32 v60, v60
    v_exp_f32 v61, v61
    v_smfmac_f32_16x16x64_bf16 a[8:11], v[12:15], v[48:55], v9
    ds_read_b128 a[44:47], v3 offset:13312
    v_exp_f32 v62, v62
    v_exp_f32 v63, v63
    v_mfma_f32_32x32x16_bf16 v[16:31], a[32:35], v[160:163], 0
    v_exp_f32 v64, v64
    v_exp_f32 v65, v65
    v_exp_f32 v66, v66
    v_mfma_f32_32x32x16_bf16 v[16:31], a[36:39], v[164:167], v[16:31]
    v_exp_f32 v67, v67
    v_exp_f32 v68, v68
    v_exp_f32 v69, v69
    v_smfmac_f32_32x32x32_bf16 v[112:127], a[60:63], v[56:63], v9
    v_exp_f32 v70, v70
    v_exp_f32 v71, v71
    v_exp_f32 v72, v72
    v_smfmac_f32_16x16x64_bf16 a[8:11], v[12:15], v[56:63], v9
    ds_read_b128 a[72:75], v3 offset:14336
    v_exp_f32 v73, v73
    v_exp_f32 v74, v74
    v_smfmac_f32_32x32x32_bf16 v[128:143], a[56:59], v[64:71], v9
    v_exp_f32 v75, v75
    v_exp_f32 v76, v76
    v_exp_f32 v77, v77
    v_smfmac_f32_16x16x64_bf16 a[12:15], v[12:15], v[64:71], v9
    ds_read_b128 a[76:79], v3 offset:15360
    v_exp_f32 v78, v78
    v_exp_f32 v79, v79
    v_mfma_f32_32x32x16_bf16 v[32:47], a[32:35], v[168:171], 0
    s_waitcnt lgkmcnt(2)
    v_exp_f32 v16, v16
    v_exp_f32 v17, v17
    v_exp_f32 v18, v18
    v_mfma_f32_32x32x16_bf16 v[32:47], a[36:39], v[172:175], v[32:47]
    v_exp_f32 v19, v19
    v_exp_f32 v20, v20
    v_exp_f32 v21, v21
    v_smfmac_f32_32x32x32_bf16 v[128:143], a[60:63], v[72:79], v9
    v_exp_f32 v22, v22
    v_exp_f32 v23, v23
    v_exp_f32 v24, v24
    v_smfmac_f32_16x16x64_bf16 a[12:15], v[12:15], v[72:79], v9
    ds_read_b128 a[16:19], v3 offset:16384
    v_exp_f32 v25, v25
    v_exp_f32 v26, v26
    v_smfmac_f32_32x32x32_bf16 v[112:127], a[64:67], v[16:23], v9
    v_exp_f32 v27, v27
    v_exp_f32 v28, v28
    v_exp_f32 v29, v29
    v_smfmac_f32_16x16x64_bf16 a[8:11], v[12:15], v[16:23], v9
    ds_read_b128 a[20:23], v3 offset:17408
    v_exp_f32 v30, v30
    v_exp_f32 v31, v31
    v_mfma_f32_32x32x16_bf16 v[48:63], a[40:43], v[160:163], 0
    v_exp_f32 v32, v32
    v_exp_f32 v33, v33
    v_exp_f32 v34, v34
    v_mfma_f32_32x32x16_bf16 v[48:63], a[44:47], v[164:167], v[48:63]
    v_exp_f32 v35, v35
    v_exp_f32 v36, v36
    v_exp_f32 v37, v37
    v_smfmac_f32_32x32x32_bf16 v[112:127], a[68:71], v[24:31], v9
    v_exp_f32 v38, v38
    v_exp_f32 v39, v39
    v_exp_f32 v40, v40
    v_smfmac_f32_16x16x64_bf16 a[8:11], v[12:15], v[24:31], v9
    ds_read_b128 a[48:51], v3 offset:18432
    v_exp_f32 v41, v41
    v_exp_f32 v42, v42
    v_smfmac_f32_32x32x32_bf16 v[128:143], a[64:67], v[32:39], v9
    v_exp_f32 v43, v43
    v_exp_f32 v44, v44
    v_exp_f32 v45, v45
    v_smfmac_f32_16x16x64_bf16 a[12:15], v[12:15], v[32:39], v9
    ds_read_b128 a[52:55], v3 offset:19456
    v_exp_f32 v46, v46
    v_exp_f32 v47, v47
    v_mfma_f32_32x32x16_bf16 v[64:79], a[40:43], v[168:171], 0
    s_waitcnt lgkmcnt(2)
    v_exp_f32 v48, v48
    v_exp_f32 v49, v49
    v_exp_f32 v50, v50
    v_mfma_f32_32x32x16_bf16 v[64:79], a[44:47], v[172:175], v[64:79]
    v_exp_f32 v51, v51
    v_exp_f32 v52, v52
    v_exp_f32 v53, v53
    v_smfmac_f32_32x32x32_bf16 v[128:143], a[68:71], v[40:47], v9
    v_exp_f32 v54, v54
    v_exp_f32 v55, v55
    v_exp_f32 v56, v56
    v_smfmac_f32_16x16x64_bf16 a[12:15], v[12:15], v[40:47], v9
    ds_read_b128 a[24:27], v3 offset:20480
    v_exp_f32 v57, v57
    v_exp_f32 v58, v58
    v_smfmac_f32_32x32x32_bf16 v[112:127], a[72:75], v[48:55], v9
    v_exp_f32 v59, v59
    v_exp_f32 v60, v60
    v_exp_f32 v61, v61
    v_smfmac_f32_16x16x64_bf16 a[8:11], v[12:15], v[48:55], v9
    ds_read_b128 a[28:31], v3 offset:21504
    v_exp_f32 v62, v62
    v_exp_f32 v63, v63
    v_mfma_f32_32x32x16_bf16 v[16:31], a[16:19], v[160:163], 0
    v_exp_f32 v64, v64
    v_exp_f32 v65, v65
    v_exp_f32 v66, v66
    v_mfma_f32_32x32x16_bf16 v[16:31], a[20:23], v[164:167], v[16:31]
    v_exp_f32 v67, v67
    v_exp_f32 v68, v68
    v_exp_f32 v69, v69
    v_smfmac_f32_32x32x32_bf16 v[112:127], a[76:79], v[56:63], v9
    v_exp_f32 v70, v70
    v_exp_f32 v71, v71
    v_exp_f32 v72, v72
    v_smfmac_f32_16x16x64_bf16 a[8:11], v[12:15], v[56:63], v9
    ds_read_b128 a[56:59], v3 offset:22528
    v_exp_f32 v73, v73
    v_exp_f32 v74, v74
    v_smfmac_f32_32x32x32_bf16 v[128:143], a[72:75], v[64:71], v9
    v_exp_f32 v75, v75
    v_exp_f32 v76, v76
    v_exp_f32 v77, v77
    v_smfmac_f32_16x16x64_bf16 a[12:15], v[12:15], v[64:71], v9
    ds_read_b128 a[60:63], v3 offset:23552
    v_exp_f32 v78, v78
    v_exp_f32 v79, v79
    v_mfma_f32_32x32x16_bf16 v[32:47], a[16:19], v[168:171], 0
    s_waitcnt lgkmcnt(2)
    v_exp_f32 v16, v16
    v_exp_f32 v17, v17
    v_exp_f32 v18, v18
    v_mfma_f32_32x32x16_bf16 v[32:47], a[20:23], v[172:175], v[32:47]
    v_exp_f32 v19, v19
    v_exp_f32 v20, v20
    v_exp_f32 v21, v21
    v_smfmac_f32_32x32x32_bf16 v[128:143], a[76:79], v[72:79], v9
    v_exp_f32 v22, v22
    v_exp_f32 v23, v23
    v_exp_f32 v24, v24
    v_smfmac_f32_16x16x64_bf16 a[12:15], v[12:15], v[72:79], v9
    ds_read_b128 a[32:35], v3 offset:24576
    v_exp_f32 v25, v25
    v_exp_f32 v26, v26
    v_smfmac_f32_32x32x32_bf16 v[112:127], a[48:51], v[16:23], v9
    v_exp_f32 v27, v27
    v_exp_f32 v28, v28
    v_exp_f32 v29, v29
    v_smfmac_f32_16x16x64_bf16 a[8:11], v[12:15], v[16:23], v9
    ds_read_b128 a[36:39], v3 offset:25600
    v_exp_f32 v30, v30
    v_exp_f32 v31, v31
    v_mfma_f32_32x32x16_bf16 v[48:63], a[24:27], v[160:163], 0
    v_exp_f32 v32, v32
    v_exp_f32 v33, v33
    v_exp_f32 v34, v34
    v_mfma_f32_32x32x16_bf16 v[48:63], a[28:31], v[164:167], v[48:63]
    v_exp_f32 v35, v35
    v_exp_f32 v36, v36
    v_exp_f32 v37, v37
    v_smfmac_f32_32x32x32_bf16 v[112:127], a[52:55], v[24:31], v9
    v_exp_f32 v38, v38
    v_exp_f32 v39, v39
    v_exp_f32 v40, v40
    v_smfmac_f32_16x16x64_bf16 a[8:11], v[12:15], v[24:31], v9
    ds_read_b128 a[64:67], v3 offset:26624
    v_exp_f32 v41, v41
    v_exp_f32 v42, v42
    v_smfmac_f32_32x32x32_bf16 v[128:143], a[48:51], v[32:39], v9
    v_exp_f32 v43, v43
    v_exp_f32 v44, v44
    v_exp_f32 v45, v45
    v_smfmac_f32_16x16x64_bf16 a[12:15], v[12:15], v[32:39], v9
    ds_read_b128 a[68:71], v3 offset:27648
    v_exp_f32 v46, v46
    v_exp_f32 v47, v47
    v_mfma_f32_32x32x16_bf16 v[64:79], a[24:27], v[168:171], 0
    s_waitcnt lgkmcnt(2)
    v_exp_f32 v48, v48
    v_exp_f32 v49, v49
    v_exp_f32 v50, v50
    v_mfma_f32_32x32x16_bf16 v[64:79], a[28:31], v[172:175], v[64:79]
    v_exp_f32 v51, v51
    v_exp_f32 v52, v52
    v_exp_f32 v53, v53
    v_smfmac_f32_32x32x32_bf16 v[128:143], a[52:55], v[40:47], v9
    v_exp_f32 v54, v54
    v_exp_f32 v55, v55
    v_exp_f32 v56, v56
    v_smfmac_f32_16x16x64_bf16 a[12:15], v[12:15], v[40:47], v9
    ds_read_b128 a[40:43], v3 offset:28672
    v_exp_f32 v57, v57
    v_exp_f32 v58, v58
    v_smfmac_f32_32x32x32_bf16 v[112:127], a[56:59], v[48:55], v9
    v_exp_f32 v59, v59
    v_exp_f32 v60, v60
    v_exp_f32 v61, v61
    v_smfmac_f32_16x16x64_bf16 a[8:11], v[12:15], v[48:55], v9
    ds_read_b128 a[44:47], v3 offset:29696
    v_exp_f32 v62, v62
    v_exp_f32 v63, v63
    v_mfma_f32_32x32x16_bf16 v[16:31], a[32:35], v[160:163], 0
    v_exp_f32 v64, v64
    v_exp_f32 v65, v65
    v_exp_f32 v66, v66
    v_mfma_f32_32x32x16_bf16 v[16:31], a[36:39], v[164:167], v[16:31]
    v_exp_f32 v67, v67
    v_exp_f32 v68, v68
    v_exp_f32 v69, v69
    v_smfmac_f32_32x32x32_bf16 v[112:127], a[60:63], v[56:63], v9
    v_exp_f32 v70, v70
    v_exp_f32 v71, v71
    v_exp_f32 v72, v72
    v_smfmac_f32_16x16x64_bf16 a[8:11], v[12:15], v[56:63], v9
    ds_read_b128 a[72:75], v3 offset:30720
    v_exp_f32 v73, v73
    v_exp_f32 v74, v74
    v_smfmac_f32_32x32x32_bf16 v[128:143], a[56:59], v[64:71], v9
    v_exp_f32 v75, v75
    v_exp_f32 v76, v76
    v_exp_f32 v77, v77
    v_smfmac_f32_16x16x64_bf16 a[12:15], v[12:15], v[64:71], v9
    ds_read_b128 a[76:79], v3 offset:31744
    v_exp_f32 v78, v78
    v_exp_f32 v79, v79
    v_mfma_f32_32x32x16_bf16 v[32:47], a[32:35], v[168:171], 0
    s_waitcnt lgkmcnt(2)
    v_exp_f32 v16, v16
    v_exp_f32 v17, v17
    v_exp_f32 v18, v18
    v_mfma_f32_32x32x16_bf16 v[32:47], a[36:39], v[172:175], v[32:47]
    v_exp_f32 v19, v19
    v_exp_f32 v20, v20
    v_exp_f32 v21, v21
    v_smfmac_f32_32x32x32_bf16 v[128:143], a[60:63], v[72:79], v9
    v_exp_f32 v22, v22
    v_exp_f32 v23, v23
    v_exp_f32 v24, v24
    v_smfmac_f32_16x16x64_bf16 a[12:15], v[12:15], v[72:79], v9
    v_exp_f32 v25, v25
    v_exp_f32 v26, v26
    v_smfmac_f32_32x32x32_bf16 v[112:127], a[64:67], v[16:23], v9
    v_exp_f32 v27, v27
    v_exp_f32 v28, v28
    v_exp_f32 v29, v29
    v_smfmac_f32_16x16x64_bf16 a[8:11], v[12:15], v[16:23], v9
    v_exp_f32 v30, v30
    v_exp_f32 v31, v31
    v_mfma_f32_32x32x16_bf16 v[48:63], a[40:43], v[160:163], 0
    s_waitcnt lgkmcnt(0)
    s_barrier
    v_exp_f32 v32, v32
    v_exp_f32 v33, v33
    v_exp_f32 v34, v34
    v_mfma_f32_32x32x16_bf16 v[48:63], a[44:47], v[164:167], v[48:63]
    v_exp_f32 v35, v35
    v_exp_f32 v36, v36
    v_exp_f32 v37, v37
    v_smfmac_f32_32x32x32_bf16 v[112:127], a[68:71], v[24:31], v9
    v_exp_f32 v38, v38
    v_exp_f32 v39, v39
    v_exp_f32 v40, v40
    v_smfmac_f32_16x16x64_bf16 a[8:11], v[12:15], v[24:31], v9
    buffer_load_dwordx4 v[80:83], v2, s[16:19], s87 offen offset:0 sc1
    v_exp_f32 v41, v41
    v_exp_f32 v42, v42
    v_smfmac_f32_32x32x32_bf16 v[128:143], a[64:67], v[32:39], v9
    v_exp_f32 v43, v43
    v_exp_f32 v44, v44
    v_exp_f32 v45, v45
    v_smfmac_f32_16x16x64_bf16 a[12:15], v[12:15], v[32:39], v9
    buffer_load_dwordx4 v[84:87], v2, s[16:19], s87 offen offset:1024 sc1
    v_exp_f32 v46, v46
    v_exp_f32 v47, v47
    v_mfma_f32_32x32x16_bf16 v[64:79], a[40:43], v[168:171], 0
    s_waitcnt lgkmcnt(0)
    v_exp_f32 v48, v48
    v_exp_f32 v49, v49
    v_exp_f32 v50, v50
    v_mfma_f32_32x32x16_bf16 v[64:79], a[44:47], v[172:175], v[64:79]
    buffer_load_dwordx4 v[88:91], v2, s[16:19], s87 offen offset:2048 sc1
    v_exp_f32 v51, v51
    v_exp_f32 v52, v52
    v_exp_f32 v53, v53
    v_smfmac_f32_32x32x32_bf16 v[128:143], a[68:71], v[40:47], v9
    v_exp_f32 v54, v54
    v_exp_f32 v55, v55
    v_exp_f32 v56, v56
    v_smfmac_f32_16x16x64_bf16 a[12:15], v[12:15], v[40:47], v9
    buffer_load_dwordx4 v[92:95], v2, s[16:19], s87 offen offset:3072 sc1
    v_exp_f32 v57, v57
    v_exp_f32 v58, v58
    v_smfmac_f32_32x32x32_bf16 v[112:127], a[72:75], v[48:55], v9
    v_exp_f32 v59, v59
    v_exp_f32 v60, v60
    v_exp_f32 v61, v61
    v_smfmac_f32_16x16x64_bf16 a[8:11], v[12:15], v[48:55], v9
    buffer_load_dwordx4 v[96:99], v2, s[16:19], s88 offen offset:0 sc1
    v_exp_f32 v62, v62
    v_exp_f32 v63, v63
    v_exp_f32 v64, v64
    v_exp_f32 v65, v65
    v_exp_f32 v66, v66
    v_exp_f32 v67, v67
    v_exp_f32 v68, v68
    v_exp_f32 v69, v69
    v_smfmac_f32_32x32x32_bf16 v[112:127], a[76:79], v[56:63], v9
    buffer_load_dwordx4 v[100:103], v2, s[16:19], s88 offen offset:1024 sc1
    v_exp_f32 v70, v70
    v_exp_f32 v71, v71
    v_exp_f32 v72, v72
    v_smfmac_f32_16x16x64_bf16 a[8:11], v[12:15], v[56:63], v9
    buffer_load_dwordx4 v[104:107], v2, s[16:19], s88 offen offset:2048 sc1
    v_exp_f32 v73, v73
    v_exp_f32 v74, v74
    v_smfmac_f32_32x32x32_bf16 v[128:143], a[72:75], v[64:71], v9
    v_exp_f32 v75, v75
    v_exp_f32 v76, v76
    v_exp_f32 v77, v77
    v_smfmac_f32_16x16x64_bf16 a[12:15], v[12:15], v[64:71], v9
    buffer_load_dwordx4 v[108:111], v2, s[16:19], s88 offen offset:3072 sc1
    v_exp_f32 v78, v78
    v_exp_f32 v79, v79
    s_nop 1
    v_smfmac_f32_16x16x64_bf16 a[12:15], v[12:15], v[72:79], v9
    v_smfmac_f32_32x32x32_bf16 v[128:143], a[76:79], v[72:79], v9
    v_accvgpr_read_b32 v0, a8
    v_rcp_f32 v8, v0
    v_min_f32 v4, v4, v0
    v_max_f32 v5, v5, v0
    v_fma_f32 v6, v0, 0, v6
    v_mul_f32 v8, v8, v10
    v_pk_mul_f32 v[112:113], v[112:113], v[8:9] op_sel_hi:[1,0]
    v_pk_mul_f32 v[114:115], v[114:115], v[8:9] op_sel_hi:[1,0]
    v_pk_mul_f32 v[116:117], v[116:117], v[8:9] op_sel_hi:[1,0]
    v_pk_mul_f32 v[118:119], v[118:119], v[8:9] op_sel_hi:[1,0]
    v_pk_fma_f32 v[6:7], v[112:113], 0, v[6:7]
    v_pk_fma_f32 v[6:7], v[114:115], 0, v[6:7]
    v_pk_fma_f32 v[6:7], v[116:117], 0, v[6:7]
    v_pk_fma_f32 v[6:7], v[118:119], 0, v[6:7]
    v_cvt_pk_bf16_f32 v112, v112, v113
    v_cvt_pk_bf16_f32 v113, v114, v115
    v_cvt_pk_bf16_f32 v114, v116, v117
    v_cvt_pk_bf16_f32 v115, v118, v119
    buffer_store_dwordx4 v[112:115], v1, s[16:19], s52 offen offset:0 sc1
    v_pk_mul_f32 v[120:121], v[120:121], v[8:9] op_sel_hi:[1,0]
    v_pk_mul_f32 v[122:123], v[122:123], v[8:9] op_sel_hi:[1,0]
    v_pk_mul_f32 v[124:125], v[124:125], v[8:9] op_sel_hi:[1,0]
    v_pk_mul_f32 v[126:127], v[126:127], v[8:9] op_sel_hi:[1,0]
    v_pk_fma_f32 v[6:7], v[120:121], 0, v[6:7]
    v_pk_fma_f32 v[6:7], v[122:123], 0, v[6:7]
    v_pk_fma_f32 v[6:7], v[124:125], 0, v[6:7]
    v_pk_fma_f32 v[6:7], v[126:127], 0, v[6:7]
    v_cvt_pk_bf16_f32 v120, v120, v121
    v_cvt_pk_bf16_f32 v121, v122, v123
    v_cvt_pk_bf16_f32 v122, v124, v125
    v_cvt_pk_bf16_f32 v123, v126, v127
    buffer_store_dwordx4 v[120:123], v1, s[16:19], s52 offen offset:512 sc1
    v_accvgpr_read_b32 v0, a12
    v_rcp_f32 v8, v0
    v_min_f32 v4, v4, v0
    v_max_f32 v5, v5, v0
    v_fma_f32 v6, v0, 0, v6
    v_mul_f32 v8, v8, v11
    v_pk_mul_f32 v[128:129], v[128:129], v[8:9] op_sel_hi:[1,0]
    v_pk_mul_f32 v[130:131], v[130:131], v[8:9] op_sel_hi:[1,0]
    v_pk_mul_f32 v[132:133], v[132:133], v[8:9] op_sel_hi:[1,0]
    v_pk_mul_f32 v[134:135], v[134:135], v[8:9] op_sel_hi:[1,0]
    v_pk_fma_f32 v[6:7], v[128:129], 0, v[6:7]
    v_pk_fma_f32 v[6:7], v[130:131], 0, v[6:7]
    v_pk_fma_f32 v[6:7], v[132:133], 0, v[6:7]
    v_pk_fma_f32 v[6:7], v[134:135], 0, v[6:7]
    v_cvt_pk_bf16_f32 v128, v128, v129
    v_cvt_pk_bf16_f32 v129, v130, v131
    v_cvt_pk_bf16_f32 v130, v132, v133
    v_cvt_pk_bf16_f32 v131, v134, v135
    buffer_store_dwordx4 v[128:131], v1, s[16:19], s53 offen offset:0 sc1
    v_pk_mul_f32 v[136:137], v[136:137], v[8:9] op_sel_hi:[1,0]
    v_pk_mul_f32 v[138:139], v[138:139], v[8:9] op_sel_hi:[1,0]
    v_pk_mul_f32 v[140:141], v[140:141], v[8:9] op_sel_hi:[1,0]
    v_pk_mul_f32 v[142:143], v[142:143], v[8:9] op_sel_hi:[1,0]
    v_pk_fma_f32 v[6:7], v[136:137], 0, v[6:7]
    v_pk_fma_f32 v[6:7], v[138:139], 0, v[6:7]
    v_pk_fma_f32 v[6:7], v[140:141], 0, v[6:7]
    v_pk_fma_f32 v[6:7], v[142:143], 0, v[6:7]
    v_cvt_pk_bf16_f32 v136, v136, v137
    v_cvt_pk_bf16_f32 v137, v138, v139
    v_cvt_pk_bf16_f32 v138, v140, v141
    v_cvt_pk_bf16_f32 v139, v142, v143
    buffer_store_dwordx4 v[136:139], v1, s[16:19], s53 offen offset:512 sc1
    v_cmp_gt_f32 vcc, 0x37800000, v4
    s_mov_b32 s29, 0x5f800000
    v_cmp_lt_f32 s[46:47], s29, v5
    v_cmp_u_f32 s[30:31], v6, v7
    s_nop 1
    s_or_b64 s[46:47], s[46:47], vcc
    s_or_b64 s[46:47], s[46:47], s[30:31]
    s_cbranch_scc1 AT_SLOW
AT_DONE:
    v_mov_b32 v5, v2
    s_add_u32 s86, s86, 8192
    s_and_b32 s86, s86, 0xffff
    s_add_u32 s87, s85, s86
    s_add_u32 s88, s87, 4096
    ds_read_b128 a[0:3], v5 offset:0
    ds_read_b128 a[4:7], v5 offset:1024
    ds_read_b128 a[8:11], v5 offset:2048
    ds_read_b128 a[12:15], v5 offset:3072
    ds_read_b128 a[16:19], v5 offset:4096
    ds_read_b128 a[20:23], v5 offset:5120
    ds_read_b128 a[24:27], v5 offset:6144
    ds_read_b128 a[28:31], v5 offset:7168
    buffer_load_dwordx4 v[144:147], v2, s[16:19], s87 offen offset:0 sc1
    buffer_load_dwordx4 v[148:151], v2, s[16:19], s87 offen offset:1024 sc1
    buffer_load_dwordx4 v[152:155], v2, s[16:19], s87 offen offset:2048 sc1
    buffer_load_dwordx4 v[156:159], v2, s[16:19], s87 offen offset:3072 sc1
    buffer_load_dwordx4 v[160:163], v2, s[16:19], s88 offen offset:0 sc1
    buffer_load_dwordx4 v[164:167], v2, s[16:19], s88 offen offset:1024 sc1
    buffer_load_dwordx4 v[168:171], v2, s[16:19], s88 offen offset:2048 sc1
    buffer_load_dwordx4 v[172:175], v2, s[16:19], s88 offen offset:3072 sc1
    s_add_u32 s86, s86, 8192
    s_and_b32 s86, s86, 0xffff
    s_add_u32 s87, s85, s86
    s_add_u32 s88, s87, 4096
    v_mov_b32 v16, 0
    v_mov_b32 v17, 0
    v_mov_b32 v18, 0
    v_mov_b32 v19, 0
    v_mov_b32 v20, 0
    v_mov_b32 v21, 0
    v_mov_b32 v22, 0
    v_mov_b32 v23, 0
    v_mov_b32 v24, 0
    v_mov_b32 v25, 0
    v_mov_b32 v26, 0
    v_mov_b32 v27, 0
    v_mov_b32 v28, 0
    v_mov_b32 v29, 0
    v_mov_b32 v30, 0
    v_mov_b32 v31, 0
    v_mov_b32 v32, 0
    v_mov_b32 v33, 0
    v_mov_b32 v34, 0
    v_mov_b32 v35, 0
    v_mov_b32 v36, 0
    v_mov_b32 v37, 0
    v_mov_b32 v38, 0
    v_mov_b32 v39, 0
    v_mov_b32 v40, 0
    v_mov_b32 v41, 0
    v_mov_b32 v42, 0
    v_mov_b32 v43, 0
    v_mov_b32 v44, 0
    v_mov_b32 v45, 0
    v_mov_b32 v46, 0
    v_mov_b32 v47, 0
    s_mov_b32 s38, 0
    v_mov_b32 v8, 0
    v_mov_b32 v0, 1
    s_mov_b32 s39, 32768
    s_mov_b32 s12, s56
    s_and_b32 s13, s57, 0xffff
    s_mov_b32 s14, 0x400000
    s_mov_b32 s15, 0x20000
    v_lshrrev_b32 v1, 4, v2
    s_lshl_b32 s44, s24, 12
    s_add_u32 s44, s44, 0x18000
    v_add_u32 v52, s44, v2
    v_and_b32 v9, 15, v1
    v_lshrrev_b32 v10, 5, v1
    v_xor_b32 v10, v10, v1
    v_and_b32 v10, 7, v10
    v_lshlrev_b32 v10, 4, v10
    v_lshl_add_u32 v10, v9, 7, v10
    v_bfe_u32 v9, v1, 4, 1
    v_lshl_add_u32 v10, v9, 3, v10
    v_add_u32 v48, s44, v10
    v_xor_b32 v49, 32, v48
    v_xor_b32 v50, 64, v48
    v_xor_b32 v51, 96, v48
    v_lshrrev_b32 v9, 3, v1
    v_xor_b32 v10, v9, v1
    v_and_b32 v10, 7, v10
    v_lshlrev_b32 v10, 4, v10
    v_lshl_add_u32 v53, v9, 11, v10
    s_lshl_b32 s40, s84, 16
    s_lshl_b32 s41, s26, 7
    s_add_u32 s40, s40, s41
    s_add_u32 s41, s40, 16384
    s_add_u32 s42, s40, 32768
    s_add_u32 s43, s40, 49152
P3_LOOP:
    s_waitcnt lgkmcnt(4) vmcnt(15)
    v_mfma_f32_16x16x32_bf16 v[16:19], a[0:3], v[80:83], v[16:19]
    s_barrier
    s_cmp_eq_u32 s38, 14
    s_cselect_b32 s18, 0, s18
    ds_read_b128 a[32:35], v5 offset:8192
    v_mfma_f32_16x16x32_bf16 v[24:27], a[4:7], v[80:83], v[24:27]
    v_mfma_f32_16x16x32_bf16 v[32:35], a[8:11], v[80:83], v[32:35]
    ds_read_b128 a[36:39], v5 offset:9216
    v_mfma_f32_16x16x32_bf16 v[40:43], a[12:15], v[80:83], v[40:43]
    buffer_load_dwordx4 v[80:83], v2, s[16:19], s87 offen offset:0 sc1
    s_waitcnt vmcnt(15)
    v_mfma_f32_16x16x32_bf16 v[20:23], a[0:3], v[84:87], v[20:23]
    ds_read_b128 a[40:43], v5 offset:10240
    v_mfma_f32_16x16x32_bf16 v[28:31], a[4:7], v[84:87], v[28:31]
    v_mfma_f32_16x16x32_bf16 v[36:39], a[8:11], v[84:87], v[36:39]
    ds_read_b128 a[44:47], v5 offset:11264
    v_mfma_f32_16x16x32_bf16 v[44:47], a[12:15], v[84:87], v[44:47]
    buffer_load_dwordx4 v[84:87], v2, s[16:19], s87 offen offset:1024 sc1
    s_waitcnt lgkmcnt(4) vmcnt(15)
    v_mfma_f32_16x16x32_bf16 v[16:19], a[16:19], v[88:91], v[16:19]
    ds_read_b128 a[48:51], v5 offset:12288
    v_mfma_f32_16x16x32_bf16 v[24:27], a[20:23], v[88:91], v[24:27]
    s_cmp_eq_u32 s38, 8
    s_cselect_b32 s31, 0xfffe0000, s39
    v_mfma_f32_16x16x32_bf16 v[32:35], a[24:27], v[88:91], v[32:35]
    ds_read_b128 a[52:55], v5 offset:13312
    v_mfma_f32_16x16x32_bf16 v[40:43], a[28:31], v[88:91], v[40:43]
    buffer_load_dwordx4 v[88:91], v2, s[16:19], s87 offen offset:2048 sc1
    s_waitcnt vmcnt(15)
    v_mfma_f32_16x16x32_bf16 v[20:23], a[16:19], v[92:95], v[20:23]
    ds_read_b128 a[56:59], v5 offset:14336
    v_mfma_f32_16x16x32_bf16 v[28:31], a[20:23], v[92:95], v[28:31]
    v_mfma_f32_16x16x32_bf16 v[36:39], a[24:27], v[92:95], v[36:39]
    ds_read_b128 a[60:63], v5 offset:15360
    v_mfma_f32_16x16x32_bf16 v[44:47], a[28:31], v[92:95], v[44:47]
    buffer_load_dwordx4 v[92:95], v2, s[16:19], s87 offen offset:3072 sc1
    s_waitcnt lgkmcnt(4) vmcnt(15)
    v_mfma_f32_16x16x32_bf16 v[16:19], a[32:35], v[96:99], v[16:19]
    ds_read_b128 a[0:3], v5 offset:16384
    v_mfma_f32_16x16x32_bf16 v[24:27], a[36:39], v[96:99], v[24:27]
    v_mfma_f32_16x16x32_bf16 v[32:35], a[40:43], v[96:99], v[32:35]
    ds_read_b128 a[4:7], v5 offset:17408
    v_mfma_f32_16x16x32_bf16 v[40:43], a[44:47], v[96:99], v[40:43]
    buffer_load_dwordx4 v[96:99], v2, s[16:19], s88 offen offset:0 sc1
    s_waitcnt vmcnt(15)
    v_mfma_f32_16x16x32_bf16 v[20:23], a[32:35], v[100:103], v[20:23]
    ds_read_b128 a[8:11], v5 offset:18432
    v_mfma_f32_16x16x32_bf16 v[28:31], a[36:39], v[100:103], v[28:31]
    v_mfma_f32_16x16x32_bf16 v[36:39], a[40:43], v[100:103], v[36:39]
    ds_read_b128 a[12:15], v5 offset:19456
    v_mfma_f32_16x16x32_bf16 v[44:47], a[44:47], v[100:103], v[44:47]
    buffer_load_dwordx4 v[100:103], v2, s[16:19], s88 offen offset:1024 sc1
    s_waitcnt lgkmcnt(4) vmcnt(15)
    v_mfma_f32_16x16x32_bf16 v[16:19], a[48:51], v[104:107], v[16:19]
    ds_read_b128 a[16:19], v5 offset:20480
    v_mfma_f32_16x16x32_bf16 v[24:27], a[52:55], v[104:107], v[24:27]
    s_add_u32 s86, s86, 8192
    v_mfma_f32_16x16x32_bf16 v[32:35], a[56:59], v[104:107], v[32:35]
    ds_read_b128 a[20:23], v5 offset:21504
    v_mfma_f32_16x16x32_bf16 v[40:43], a[60:63], v[104:107], v[40:43]
    buffer_load_dwordx4 v[104:107], v2, s[16:19], s88 offen offset:2048 sc1
    s_waitcnt vmcnt(15)
    v_mfma_f32_16x16x32_bf16 v[20:23], a[48:51], v[108:111], v[20:23]
    ds_read_b128 a[24:27], v5 offset:22528
    v_mfma_f32_16x16x32_bf16 v[28:31], a[52:55], v[108:111], v[28:31]
    s_and_b32 s86, s86, 0xffff
    s_add_u32 s87, s85, s86
    v_mfma_f32_16x16x32_bf16 v[36:39], a[56:59], v[108:111], v[36:39]
    ds_read_b128 a[28:31], v5 offset:23552
    v_mfma_f32_16x16x32_bf16 v[44:47], a[60:63], v[108:111], v[44:47]
    buffer_load_dwordx4 v[108:111], v2, s[16:19], s88 offen offset:3072 sc1
    s_add_u32 s88, s87, 4096
    s_waitcnt lgkmcnt(4) vmcnt(15)
    v_mfma_f32_16x16x32_bf16 v[16:19], a[0:3], v[144:147], v[16:19]
    ds_read_b128 a[32:35], v5 offset:24576
    v_mfma_f32_16x16x32_bf16 v[24:27], a[4:7], v[144:147], v[24:27]
    v_mfma_f32_16x16x32_bf16 v[32:35], a[8:11], v[144:147], v[32:35]
    ds_read_b128 a[36:39], v5 offset:25600
    v_mfma_f32_16x16x32_bf16 v[40:43], a[12:15], v[144:147], v[40:43]
    buffer_load_dwordx4 v[144:147], v2, s[16:19], s87 offen offset:0 sc1
    s_waitcnt vmcnt(15)
    v_mfma_f32_16x16x32_bf16 v[20:23], a[0:3], v[148:151], v[20:23]
    ds_read_b128 a[40:43], v5 offset:26624
    v_mfma_f32_16x16x32_bf16 v[28:31], a[4:7], v[148:151], v[28:31]
    v_mfma_f32_16x16x32_bf16 v[36:39], a[8:11], v[148:151], v[36:39]
    ds_read_b128 a[44:47], v5 offset:27648
    v_mfma_f32_16x16x32_bf16 v[44:47], a[12:15], v[148:151], v[44:47]
    buffer_load_dwordx4 v[148:151], v2, s[16:19], s87 offen offset:1024 sc1
    s_waitcnt lgkmcnt(4) vmcnt(15)
    v_mfma_f32_16x16x32_bf16 v[16:19], a[16:19], v[152:155], v[16:19]
    ds_read_b128 a[48:51], v5 offset:28672
    v_mfma_f32_16x16x32_bf16 v[24:27], a[20:23], v[152:155], v[24:27]
    v_mfma_f32_16x16x32_bf16 v[32:35], a[24:27], v[152:155], v[32:35]
    ds_read_b128 a[52:55], v5 offset:29696
    v_mfma_f32_16x16x32_bf16 v[40:43], a[28:31], v[152:155], v[40:43]
    buffer_load_dwordx4 v[152:155], v2, s[16:19], s87 offen offset:2048 sc1
    s_waitcnt vmcnt(15)
    v_mfma_f32_16x16x32_bf16 v[20:23], a[16:19], v[156:159], v[20:23]
    ds_read_b128 a[56:59], v5 offset:30720
    v_mfma_f32_16x16x32_bf16 v[28:31], a[20:23], v[156:159], v[28:31]
    s_cmp_eq_u32 s38, 0
    s_cselect_b32 s29, s55, 0x40000000
    s_mov_b64 exec, 1
    buffer_atomic_add v0, v8, s[16:19], s29 offen offset:128 sc1
    s_mov_b64 exec, -1
    v_mfma_f32_16x16x32_bf16 v[36:39], a[24:27], v[156:159], v[36:39]
    ds_read_b128 a[60:63], v5 offset:31744
    v_mfma_f32_16x16x32_bf16 v[44:47], a[28:31], v[156:159], v[44:47]
    buffer_load_dwordx4 v[156:159], v2, s[16:19], s87 offen offset:3072 sc1
    v_add_u32 v5, s31, v5
    s_waitcnt lgkmcnt(4) vmcnt(15)
    v_mfma_f32_16x16x32_bf16 v[16:19], a[32:35], v[160:163], v[16:19]
    ds_read_b128 a[0:3], v5 offset:0
    v_mfma_f32_16x16x32_bf16 v[24:27], a[36:39], v[160:163], v[24:27]
    v_mfma_f32_16x16x32_bf16 v[32:35], a[40:43], v[160:163], v[32:35]
    ds_read_b128 a[4:7], v5 offset:1024
    v_mfma_f32_16x16x32_bf16 v[40:43], a[44:47], v[160:163], v[40:43]
    buffer_load_dwordx4 v[160:163], v2, s[16:19], s88 offen offset:0 sc1
    s_waitcnt vmcnt(15)
    v_mfma_f32_16x16x32_bf16 v[20:23], a[32:35], v[164:167], v[20:23]
    ds_read_b128 a[8:11], v5 offset:2048
    v_mfma_f32_16x16x32_bf16 v[28:31], a[36:39], v[164:167], v[28:31]
    v_mfma_f32_16x16x32_bf16 v[36:39], a[40:43], v[164:167], v[36:39]
    ds_read_b128 a[12:15], v5 offset:3072
    v_mfma_f32_16x16x32_bf16 v[44:47], a[44:47], v[164:167], v[44:47]
    buffer_load_dwordx4 v[164:167], v2, s[16:19], s88 offen offset:1024 sc1
    s_waitcnt lgkmcnt(4) vmcnt(15)
    v_mfma_f32_16x16x32_bf16 v[16:19], a[48:51], v[168:171], v[16:19]
    ds_read_b128 a[16:19], v5 offset:4096
    v_mfma_f32_16x16x32_bf16 v[24:27], a[52:55], v[168:171], v[24:27]
    s_cmp_eq_u32 s38, 4
    s_cselect_b32 s29, 0x10000, 0
    s_add_u32 s86, s86, 8192
    v_mfma_f32_16x16x32_bf16 v[32:35], a[56:59], v[168:171], v[32:35]
    ds_read_b128 a[20:23], v5 offset:5120
    v_mfma_f32_16x16x32_bf16 v[40:43], a[60:63], v[168:171], v[40:43]
    buffer_load_dwordx4 v[168:171], v2, s[16:19], s88 offen offset:2048 sc1
    s_waitcnt vmcnt(15)
    v_mfma_f32_16x16x32_bf16 v[20:23], a[48:51], v[172:175], v[20:23]
    ds_read_b128 a[24:27], v5 offset:6144
    v_mfma_f32_16x16x32_bf16 v[28:31], a[52:55], v[172:175], v[28:31]
    s_add_u32 s85, s85, s29
    s_and_b32 s86, s86, 0xffff
    s_add_u32 s87, s85, s86
    v_mfma_f32_16x16x32_bf16 v[36:39], a[56:59], v[172:175], v[36:39]
    ds_read_b128 a[28:31], v5 offset:7168
    v_mfma_f32_16x16x32_bf16 v[44:47], a[60:63], v[172:175], v[44:47]
    buffer_load_dwordx4 v[172:175], v2, s[16:19], s88 offen offset:3072 sc1
    s_add_u32 s88, s87, 4096
    s_add_u32 s38, s38, 2
    s_cmp_lt_u32 s38, 16
    s_cbranch_scc1 P3_LOOP
    s_nop 1
    v_cvt_pk_bf16_f32 v56, v16, v17
    v_cvt_pk_bf16_f32 v57, v18, v19
    ds_write_b64 v48, v[56:57] offset:0
    v_cvt_pk_bf16_f32 v58, v24, v25
    v_cvt_pk_bf16_f32 v59, v26, v27
    ds_write_b64 v49, v[58:59] offset:0
    v_cvt_pk_bf16_f32 v60, v32, v33
    v_cvt_pk_bf16_f32 v61, v34, v35
    ds_write_b64 v50, v[60:61] offset:0
    v_cvt_pk_bf16_f32 v62, v40, v41
    v_cvt_pk_bf16_f32 v63, v42, v43
    ds_write_b64 v51, v[62:63] offset:0
    v_cvt_pk_bf16_f32 v64, v20, v21
    v_cvt_pk_bf16_f32 v65, v22, v23
    ds_write_b64 v48, v[64:65] offset:2048
    v_cvt_pk_bf16_f32 v66, v28, v29
    v_cvt_pk_bf16_f32 v67, v30, v31
    ds_write_b64 v49, v[66:67] offset:2048
    v_cvt_pk_bf16_f32 v68, v36, v37
    v_cvt_pk_bf16_f32 v69, v38, v39
    ds_write_b64 v50, v[68:69] offset:2048
    v_cvt_pk_bf16_f32 v70, v44, v45
    v_cvt_pk_bf16_f32 v71, v46, v47
    ds_write_b64 v51, v[70:71] offset:2048
    s_waitcnt lgkmcnt(0)
    ds_read_b128 v[56:59], v52 offset:0
    ds_read_b128 v[60:63], v52 offset:1024
    ds_read_b128 v[64:67], v52 offset:2048
    ds_read_b128 v[68:71], v52 offset:3072
    s_waitcnt lgkmcnt(3)
    buffer_store_dwordx4 v[56:59], v53, s[12:15], s40 offen sc1
    s_waitcnt lgkmcnt(2)
    buffer_store_dwordx4 v[60:63], v53, s[12:15], s41 offen sc1
    s_waitcnt lgkmcnt(1)
    buffer_store_dwordx4 v[64:67], v53, s[12:15], s42 offen sc1
    s_waitcnt lgkmcnt(0)
    buffer_store_dwordx4 v[68:71], v53, s[12:15], s43 offen sc1
END:
END2:
    s_endpgm
AT_SLOW:
    s_waitcnt vmcnt(0) lgkmcnt(0)
    s_nop 15
    v_mov_b32 v4, 0xff800000
    v_mov_b32 v5, 0xff800000
    v_mov_b32 v6, 0xff800000
    v_mov_b32 v7, 0xff800000
    s_mov_b32 s34, s32
    s_mov_b32 s36, 64
SL_MAX:
    buffer_load_dwordx4 a[16:19], v2, s[16:19], s34 offen sc1
    buffer_load_dwordx4 a[20:23], v2, s[16:19], s34 offen offset:1024 sc1
    s_waitcnt vmcnt(0)
    v_mfma_f32_32x32x16_bf16 v[16:31], a[16:19], v[144:147], 0
    v_mfma_f32_32x32x16_bf16 v[16:31], a[20:23], v[148:151], v[16:31]
    v_mfma_f32_32x32x16_bf16 v[32:47], a[16:19], v[152:155], 0
    v_mfma_f32_32x32x16_bf16 v[32:47], a[20:23], v[156:159], v[32:47]
    v_mfma_f32_32x32x16_bf16 v[48:63], a[16:19], v[160:163], 0
    v_mfma_f32_32x32x16_bf16 v[48:63], a[20:23], v[164:167], v[48:63]
    v_mfma_f32_32x32x16_bf16 v[64:79], a[16:19], v[168:171], 0
    v_mfma_f32_32x32x16_bf16 v[64:79], a[20:23], v[172:175], v[64:79]
    s_nop 15
    v_max3_f32 v4, v4, v16, v17
    v_max3_f32 v4, v4, v18, v19
    v_max3_f32 v4, v4, v20, v21
    v_max3_f32 v4, v4, v22, v23
    v_max3_f32 v4, v4, v24, v25
    v_max3_f32 v4, v4, v26, v27
    v_max3_f32 v4, v4, v28, v29
    v_max3_f32 v4, v4, v30, v31
    v_max3_f32 v5, v5, v32, v33
    v_max3_f32 v5, v5, v34, v35
    v_max3_f32 v5, v5, v36, v37
    v_max3_f32 v5, v5, v38, v39
    v_max3_f32 v5, v5, v40, v41
    v_max3_f32 v5, v5, v42, v43
    v_max3_f32 v5, v5, v44, v45
    v_max3_f32 v5, v5, v46, v47
    v_max3_f32 v6, v6, v48, v49
    v_max3_f32 v6, v6, v50, v51
    v_max3_f32 v6, v6, v52, v53
    v_max3_f32 v6, v6, v54, v55
    v_max3_f32 v6, v6, v56, v57
    v_max3_f32 v6, v6, v58, v59
    v_max3_f32 v6, v6, v60, v61
    v_max3_f32 v6, v6, v62, v63
    v_max3_f32 v7, v7, v64, v65
    v_max3_f32 v7, v7, v66, v67
    v_max3_f32 v7, v7, v68, v69
    v_max3_f32 v7, v7, v70, v71
    v_max3_f32 v7, v7, v72, v73
    v_max3_f32 v7, v7, v74, v75
    v_max3_f32 v7, v7, v76, v77
    v_max3_f32 v7, v7, v78, v79
    s_add_u32 s34, s34, 4096
    s_sub_u32 s36, s36, 1
    s_cmp_lg_u32 s36, 0
    s_cbranch_scc1 SL_MAX
    v_mov_b32 v8, v4
    s_nop 1
    v_permlane32_swap_b32 v8, v4
    s_nop 1
    v_max_f32 v4, v4, v8
    v_mov_b32 v8, v5
    s_nop 1
    v_permlane32_swap_b32 v8, v5
    s_nop 1
    v_max_f32 v5, v5, v8
    v_mov_b32 v8, v6
    s_nop 1
    v_permlane32_swap_b32 v8, v6
    s_nop 1
    v_max_f32 v6, v6, v8
    v_mov_b32 v8, v7
    s_nop 1
    v_permlane32_swap_b32 v8, v7
    s_nop 1
    v_max_f32 v7, v7, v8
    v_accvgpr_write_b32 a0, 0
    v_accvgpr_write_b32 a1, 0
    v_accvgpr_write_b32 a2, 0
    v_accvgpr_write_b32 a3, 0
    v_accvgpr_write_b32 a4, 0
    v_accvgpr_write_b32 a5, 0
    v_accvgpr_write_b32 a6, 0
    v_accvgpr_write_b32 a7, 0
    v_accvgpr_write_b32 a8, 0
    v_accvgpr_write_b32 a9, 0
    v_accvgpr_write_b32 a10, 0
    v_accvgpr_write_b32 a11, 0
    v_accvgpr_write_b32 a12, 0
    v_accvgpr_write_b32 a13, 0
    v_accvgpr_write_b32 a14, 0
    v_accvgpr_write_b32 a15, 0
    v_mov_b32 v80, 0
    v_mov_b32 v81, 0
    v_mov_b32 v82, 0
    v_mov_b32 v83, 0
    v_mov_b32 v84, 0
    v_mov_b32 v85, 0
    v_mov_b32 v86, 0
    v_mov_b32 v87, 0
    v_mov_b32 v88, 0
    v_mov_b32 v89, 0
    v_mov_b32 v90, 0
    v_mov_b32 v91, 0
    v_mov_b32 v92, 0
    v_mov_b32 v93, 0
    v_mov_b32 v94, 0
    v_mov_b32 v95, 0
    v_mov_b32 v96, 0
    v_mov_b32 v97, 0
    v_mov_b32 v98, 0
    v_mov_b32 v99, 0
    v_mov_b32 v100, 0
    v_mov_b32 v101, 0
    v_mov_b32 v102, 0
    v_mov_b32 v103, 0
    v_mov_b32 v104, 0
    v_mov_b32 v105, 0
    v_mov_b32 v106, 0
    v_mov_b32 v107, 0
    v_mov_b32 v108, 0
    v_mov_b32 v109, 0
    v_mov_b32 v110, 0
    v_mov_b32 v111, 0
    v_mov_b32 v112, 0
    v_mov_b32 v113, 0
    v_mov_b32 v114, 0
    v_mov_b32 v115, 0
    v_mov_b32 v116, 0
    v_mov_b32 v117, 0
    v_mov_b32 v118, 0
    v_mov_b32 v119, 0
    v_mov_b32 v120, 0
    v_mov_b32 v121, 0
    v_mov_b32 v122, 0
    v_mov_b32 v123, 0
    v_mov_b32 v124, 0
    v_mov_b32 v125, 0
    v_mov_b32 v126, 0
    v_mov_b32 v127, 0
    v_mov_b32 v128, 0
    v_mov_b32 v129, 0
    v_mov_b32 v130, 0
    v_mov_b32 v131, 0
    v_mov_b32 v132, 0
    v_mov_b32 v133, 0
    v_mov_b32 v134, 0
    v_mov_b32 v135, 0
    v_mov_b32 v136, 0
    v_mov_b32 v137, 0
    v_mov_b32 v138, 0
    v_mov_b32 v139, 0
    v_mov_b32 v140, 0
    v_mov_b32 v141, 0
    v_mov_b32 v142, 0
    v_mov_b32 v143, 0
    s_mov_b32 s34, s32
    s_mov_b32 s36, 64
SL_ACC:
    buffer_load_dwordx4 a[16:19], v2, s[16:19], s34 offen sc1
    buffer_load_dwordx4 a[20:23], v2, s[16:19], s34 offen offset:1024 sc1
    buffer_load_dwordx4 a[48:51], v2, s[16:19], s34 offen offset:2048 sc1
    buffer_load_dwordx4 a[52:55], v2, s[16:19], s34 offen offset:3072 sc1
    s_waitcnt vmcnt(0)
    v_mfma_f32_32x32x16_bf16 v[16:31], a[16:19], v[144:147], 0
    v_mfma_f32_32x32x16_bf16 v[16:31], a[20:23], v[148:151], v[16:31]
    v_mfma_f32_32x32x16_bf16 v[32:47], a[16:19], v[152:155], 0
    v_mfma_f32_32x32x16_bf16 v[32:47], a[20:23], v[156:159], v[32:47]
    v_mfma_f32_32x32x16_bf16 v[48:63], a[16:19], v[160:163], 0
    v_mfma_f32_32x32x16_bf16 v[48:63], a[20:23], v[164:167], v[48:63]
    v_mfma_f32_32x32x16_bf16 v[64:79], a[16:19], v[168:171], 0
    v_mfma_f32_32x32x16_bf16 v[64:79], a[20:23], v[172:175], v[64:79]
    s_nop 15
    v_sub_f32 v16, v16, v4
    v_sub_f32 v17, v17, v4
    v_sub_f32 v18, v18, v4
    v_sub_f32 v19, v19, v4
    v_sub_f32 v20, v20, v4
    v_sub_f32 v21, v21, v4
    v_sub_f32 v22, v22, v4
    v_sub_f32 v23, v23, v4
    v_sub_f32 v24, v24, v4
    v_sub_f32 v25, v25, v4
    v_sub_f32 v26, v26, v4
    v_sub_f32 v27, v27, v4
    v_sub_f32 v28, v28, v4
    v_sub_f32 v29, v29, v4
    v_sub_f32 v30, v30, v4
    v_sub_f32 v31, v31, v4
    v_exp_f32 v16, v16
    v_exp_f32 v17, v17
    v_exp_f32 v18, v18
    v_exp_f32 v19, v19
    v_exp_f32 v20, v20
    v_exp_f32 v21, v21
    v_exp_f32 v22, v22
    v_exp_f32 v23, v23
    v_exp_f32 v24, v24
    v_exp_f32 v25, v25
    v_exp_f32 v26, v26
    v_exp_f32 v27, v27
    v_exp_f32 v28, v28
    v_exp_f32 v29, v29
    v_exp_f32 v30, v30
    v_exp_f32 v31, v31
    v_sub_f32 v32, v32, v5
    v_sub_f32 v33, v33, v5
    v_sub_f32 v34, v34, v5
    v_sub_f32 v35, v35, v5
    v_sub_f32 v36, v36, v5
    v_sub_f32 v37, v37, v5
    v_sub_f32 v38, v38, v5
    v_sub_f32 v39, v39, v5
    v_sub_f32 v40, v40, v5
    v_sub_f32 v41, v41, v5
    v_sub_f32 v42, v42, v5
    v_sub_f32 v43, v43, v5
    v_sub_f32 v44, v44, v5
    v_sub_f32 v45, v45, v5
    v_sub_f32 v46, v46, v5
    v_sub_f32 v47, v47, v5
    v_exp_f32 v32, v32
    v_exp_f32 v33, v33
    v_exp_f32 v34, v34
    v_exp_f32 v35, v35
    v_exp_f32 v36, v36
    v_exp_f32 v37, v37
    v_exp_f32 v38, v38
    v_exp_f32 v39, v39
    v_exp_f32 v40, v40
    v_exp_f32 v41, v41
    v_exp_f32 v42, v42
    v_exp_f32 v43, v43
    v_exp_f32 v44, v44
    v_exp_f32 v45, v45
    v_exp_f32 v46, v46
    v_exp_f32 v47, v47
    v_sub_f32 v48, v48, v6
    v_sub_f32 v49, v49, v6
    v_sub_f32 v50, v50, v6
    v_sub_f32 v51, v51, v6
    v_sub_f32 v52, v52, v6
    v_sub_f32 v53, v53, v6
    v_sub_f32 v54, v54, v6
    v_sub_f32 v55, v55, v6
    v_sub_f32 v56, v56, v6
    v_sub_f32 v57, v57, v6
    v_sub_f32 v58, v58, v6
    v_sub_f32 v59, v59, v6
    v_sub_f32 v60, v60, v6
    v_sub_f32 v61, v61, v6
    v_sub_f32 v62, v62, v6
    v_sub_f32 v63, v63, v6
    v_exp_f32 v48, v48
    v_exp_f32 v49, v49
    v_exp_f32 v50, v50
    v_exp_f32 v51, v51
    v_exp_f32 v52, v52
    v_exp_f32 v53, v53
    v_exp_f32 v54, v54
    v_exp_f32 v55, v55
    v_exp_f32 v56, v56
    v_exp_f32 v57, v57
    v_exp_f32 v58, v58
    v_exp_f32 v59, v59
    v_exp_f32 v60, v60
    v_exp_f32 v61, v61
    v_exp_f32 v62, v62
    v_exp_f32 v63, v63
    v_sub_f32 v64, v64, v7
    v_sub_f32 v65, v65, v7
    v_sub_f32 v66, v66, v7
    v_sub_f32 v67, v67, v7
    v_sub_f32 v68, v68, v7
    v_sub_f32 v69, v69, v7
    v_sub_f32 v70, v70, v7
    v_sub_f32 v71, v71, v7
    v_sub_f32 v72, v72, v7
    v_sub_f32 v73, v73, v7
    v_sub_f32 v74, v74, v7
    v_sub_f32 v75, v75, v7
    v_sub_f32 v76, v76, v7
    v_sub_f32 v77, v77, v7
    v_sub_f32 v78, v78, v7
    v_sub_f32 v79, v79, v7
    v_exp_f32 v64, v64
    v_exp_f32 v65, v65
    v_exp_f32 v66, v66
    v_exp_f32 v67, v67
    v_exp_f32 v68, v68
    v_exp_f32 v69, v69
    v_exp_f32 v70, v70
    v_exp_f32 v71, v71
    v_exp_f32 v72, v72
    v_exp_f32 v73, v73
    v_exp_f32 v74, v74
    v_exp_f32 v75, v75
    v_exp_f32 v76, v76
    v_exp_f32 v77, v77
    v_exp_f32 v78, v78
    v_exp_f32 v79, v79
    s_nop 3
    v_smfmac_f32_32x32x32_bf16 v[80:95], a[48:51], v[16:23], v9
    v_smfmac_f32_16x16x64_bf16 a[0:3], v[12:15], v[16:23], v9
    v_smfmac_f32_32x32x32_bf16 v[80:95], a[52:55], v[24:31], v9
    v_smfmac_f32_16x16x64_bf16 a[0:3], v[12:15], v[24:31], v9
    v_smfmac_f32_32x32x32_bf16 v[96:111], a[48:51], v[32:39], v9
    v_smfmac_f32_16x16x64_bf16 a[4:7], v[12:15], v[32:39], v9
    v_smfmac_f32_32x32x32_bf16 v[96:111], a[52:55], v[40:47], v9
    v_smfmac_f32_16x16x64_bf16 a[4:7], v[12:15], v[40:47], v9
    v_smfmac_f32_32x32x32_bf16 v[112:127], a[48:51], v[48:55], v9
    v_smfmac_f32_16x16x64_bf16 a[8:11], v[12:15], v[48:55], v9
    v_smfmac_f32_32x32x32_bf16 v[112:127], a[52:55], v[56:63], v9
    v_smfmac_f32_16x16x64_bf16 a[8:11], v[12:15], v[56:63], v9
    v_smfmac_f32_32x32x32_bf16 v[128:143], a[48:51], v[64:71], v9
    v_smfmac_f32_16x16x64_bf16 a[12:15], v[12:15], v[64:71], v9
    v_smfmac_f32_32x32x32_bf16 v[128:143], a[52:55], v[72:79], v9
    v_smfmac_f32_16x16x64_bf16 a[12:15], v[12:15], v[72:79], v9
    s_add_u32 s34, s34, 4096
    s_sub_u32 s36, s36, 1
    s_cmp_lg_u32 s36, 0
    s_cbranch_scc1 SL_ACC
    s_nop 15
    v_accvgpr_read_b32 v0, a8
    v_rcp_f32 v8, v0
    s_nop 0
    v_mul_f32 v8, v8, v10
    v_pk_mul_f32 v[112:113], v[112:113], v[8:9] op_sel_hi:[1,0]
    v_pk_mul_f32 v[114:115], v[114:115], v[8:9] op_sel_hi:[1,0]
    v_pk_mul_f32 v[116:117], v[116:117], v[8:9] op_sel_hi:[1,0]
    v_pk_mul_f32 v[118:119], v[118:119], v[8:9] op_sel_hi:[1,0]
    v_cvt_pk_bf16_f32 v112, v112, v113
    v_cvt_pk_bf16_f32 v113, v114, v115
    v_cvt_pk_bf16_f32 v114, v116, v117
    v_cvt_pk_bf16_f32 v115, v118, v119
    buffer_store_dwordx4 v[112:115], v1, s[16:19], s52 offen offset:0 sc1
    v_pk_mul_f32 v[120:121], v[120:121], v[8:9] op_sel_hi:[1,0]
    v_pk_mul_f32 v[122:123], v[122:123], v[8:9] op_sel_hi:[1,0]
    v_pk_mul_f32 v[124:125], v[124:125], v[8:9] op_sel_hi:[1,0]
    v_pk_mul_f32 v[126:127], v[126:127], v[8:9] op_sel_hi:[1,0]
    v_cvt_pk_bf16_f32 v120, v120, v121
    v_cvt_pk_bf16_f32 v121, v122, v123
    v_cvt_pk_bf16_f32 v122, v124, v125
    v_cvt_pk_bf16_f32 v123, v126, v127
    buffer_store_dwordx4 v[120:123], v1, s[16:19], s52 offen offset:512 sc1
    v_accvgpr_read_b32 v0, a12
    v_rcp_f32 v8, v0
    s_nop 0
    v_mul_f32 v8, v8, v11
    v_pk_mul_f32 v[128:129], v[128:129], v[8:9] op_sel_hi:[1,0]
    v_pk_mul_f32 v[130:131], v[130:131], v[8:9] op_sel_hi:[1,0]
    v_pk_mul_f32 v[132:133], v[132:133], v[8:9] op_sel_hi:[1,0]
    v_pk_mul_f32 v[134:135], v[134:135], v[8:9] op_sel_hi:[1,0]
    v_cvt_pk_bf16_f32 v128, v128, v129
    v_cvt_pk_bf16_f32 v129, v130, v131
    v_cvt_pk_bf16_f32 v130, v132, v133
    v_cvt_pk_bf16_f32 v131, v134, v135
    buffer_store_dwordx4 v[128:131], v1, s[16:19], s53 offen offset:0 sc1
    v_pk_mul_f32 v[136:137], v[136:137], v[8:9] op_sel_hi:[1,0]
    v_pk_mul_f32 v[138:139], v[138:139], v[8:9] op_sel_hi:[1,0]
    v_pk_mul_f32 v[140:141], v[140:141], v[8:9] op_sel_hi:[1,0]
    v_pk_mul_f32 v[142:143], v[142:143], v[8:9] op_sel_hi:[1,0]
    v_cvt_pk_bf16_f32 v136, v136, v137
    v_cvt_pk_bf16_f32 v137, v138, v139
    v_cvt_pk_bf16_f32 v138, v140, v141
    v_cvt_pk_bf16_f32 v139, v142, v143
    buffer_store_dwordx4 v[136:139], v1, s[16:19], s53 offen offset:512 sc1
    s_cmp_eq_u32 s54, 0
    s_cbranch_scc1 SL_END
    v_accvgpr_read_b32 v0, a0
    v_rcp_f32 v8, v0
    s_nop 0
    v_mul_f32 v8, v8, v10
    v_pk_mul_f32 v[80:81], v[80:81], v[8:9] op_sel_hi:[1,0]
    v_pk_mul_f32 v[82:83], v[82:83], v[8:9] op_sel_hi:[1,0]
    v_pk_mul_f32 v[84:85], v[84:85], v[8:9] op_sel_hi:[1,0]
    v_pk_mul_f32 v[86:87], v[86:87], v[8:9] op_sel_hi:[1,0]
    v_cvt_pk_bf16_f32 v80, v80, v81
    v_cvt_pk_bf16_f32 v81, v82, v83
    v_cvt_pk_bf16_f32 v82, v84, v85
    v_cvt_pk_bf16_f32 v83, v86, v87
    buffer_store_dwordx4 v[80:83], v1, s[16:19], s50 offen offset:0 sc1
    v_pk_mul_f32 v[88:89], v[88:89], v[8:9] op_sel_hi:[1,0]
    v_pk_mul_f32 v[90:91], v[90:91], v[8:9] op_sel_hi:[1,0]
    v_pk_mul_f32 v[92:93], v[92:93], v[8:9] op_sel_hi:[1,0]
    v_pk_mul_f32 v[94:95], v[94:95], v[8:9] op_sel_hi:[1,0]
    v_cvt_pk_bf16_f32 v88, v88, v89
    v_cvt_pk_bf16_f32 v89, v90, v91
    v_cvt_pk_bf16_f32 v90, v92, v93
    v_cvt_pk_bf16_f32 v91, v94, v95
    buffer_store_dwordx4 v[88:91], v1, s[16:19], s50 offen offset:512 sc1
    v_accvgpr_read_b32 v0, a4
    v_rcp_f32 v8, v0
    s_nop 0
    v_mul_f32 v8, v8, v11
    v_pk_mul_f32 v[96:97], v[96:97], v[8:9] op_sel_hi:[1,0]
    v_pk_mul_f32 v[98:99], v[98:99], v[8:9] op_sel_hi:[1,0]
    v_pk_mul_f32 v[100:101], v[100:101], v[8:9] op_sel_hi:[1,0]
    v_pk_mul_f32 v[102:103], v[102:103], v[8:9] op_sel_hi:[1,0]
    v_cvt_pk_bf16_f32 v96, v96, v97
    v_cvt_pk_bf16_f32 v97, v98, v99
    v_cvt_pk_bf16_f32 v98, v100, v101
    v_cvt_pk_bf16_f32 v99, v102, v103
    buffer_store_dwordx4 v[96:99], v1, s[16:19], s51 offen offset:0 sc1
    v_pk_mul_f32 v[104:105], v[104:105], v[8:9] op_sel_hi:[1,0]
    v_pk_mul_f32 v[106:107], v[106:107], v[8:9] op_sel_hi:[1,0]
    v_pk_mul_f32 v[108:109], v[108:109], v[8:9] op_sel_hi:[1,0]
    v_pk_mul_f32 v[110:111], v[110:111], v[8:9] op_sel_hi:[1,0]
    v_cvt_pk_bf16_f32 v104, v104, v105
    v_cvt_pk_bf16_f32 v105, v106, v107
    v_cvt_pk_bf16_f32 v106, v108, v109
    v_cvt_pk_bf16_f32 v107, v110, v111
    buffer_store_dwordx4 v[104:107], v1, s[16:19], s51 offen offset:512 sc1
    s_waitcnt vmcnt(0)
    v_mov_b32 v8, 0
    v_mov_b32 v0, 1
    s_mov_b64 exec, 1
    buffer_atomic_add v0, v8, s[16:19], s55 offen offset:0 sc1
    s_mov_b64 exec, -1
    s_barrier
SL_END:
    s_waitcnt vmcnt(0)
    buffer_load_dwordx4 v[80:83], v2, s[16:19], s87 offen offset:0 sc1
    buffer_load_dwordx4 v[84:87], v2, s[16:19], s87 offen offset:1024 sc1
    buffer_load_dwordx4 v[88:91], v2, s[16:19], s87 offen offset:2048 sc1
    buffer_load_dwordx4 v[92:95], v2, s[16:19], s87 offen offset:3072 sc1
    buffer_load_dwordx4 v[96:99], v2, s[16:19], s88 offen offset:0 sc1
    buffer_load_dwordx4 v[100:103], v2, s[16:19], s88 offen offset:1024 sc1
    buffer_load_dwordx4 v[104:107], v2, s[16:19], s88 offen offset:2048 sc1
    buffer_load_dwordx4 v[108:111], v2, s[16:19], s88 offen offset:3072 sc1
    s_branch AT_DONE
.section .rodata,"a"
.p2align 6
.amdhsa_kernel gated_mix__grouped_kv_mqa__grouped_kv_mqa__prompt_kernel
  .amdhsa_next_free_vgpr 256
  .amdhsa_next_free_sgpr 96
  .amdhsa_accum_offset 176
  .amdhsa_group_segment_fixed_size 0
  .amdhsa_kernarg_size 112
  .amdhsa_user_sgpr_count 2
  .amdhsa_user_sgpr_kernarg_segment_ptr 1
  .amdhsa_system_sgpr_workgroup_id_x 1
.end_amdhsa_kernel
```
